```python
import torch

def _softmax(x, axis=-1):
    return torch.softmax(x, dim=axis)
def _gelu(x):
    return torch.nn.functional.gelu(x, approximate="tanh")
def _silu(x):
    return torch.nn.functional.silu(x)
def _sigmoid(x):
    return torch.sigmoid(x)
def _layernorm(x, axis=-1, eps=1e-5):
    m = x.mean(dim=axis, keepdim=True)
    v = x.var(dim=axis, keepdim=True, unbiased=False)
    return (x - m) / torch.sqrt(v + eps)
def _scatter_add(tgt, idx, src, axis=0):
    return tgt.clone().index_add_(axis, idx, src)
def _segment_sum(src, seg, n):
    out = torch.zeros((n,) + src.shape[1:], dtype=src.dtype)
    return out.index_add_(0, seg, src)
def _pad(x, pw):
    flat = tuple(v for pair in reversed(pw) for v in pair)
    return torch.nn.functional.pad(x, flat)

kernel_name = 'recurrent_scan__compressed_kv_cla__dense_activation_gelu__decode'

def setup_inputs():

    _w = (lambda a: (lambda t: t.to(torch.bfloat16) if t.is_floating_point() else t)(torch.as_tensor(a)))
    def _A_setup():
        B, H, Sq, Sk, D, M = 4, 32, 1, 4096, 128, 512
        Dc = 4 * D
        return {
            "x": _w((lambda *s: torch.randn(*s, dtype=torch.bfloat16) * 0.1)(B, Sq, M)),
            "c_kv": _w((lambda *s: torch.randn(*s, dtype=torch.bfloat16) * 3.2)(B, Sk, Dc)),
            "w_q": _w((lambda *s: torch.randn(*s, dtype=torch.bfloat16) * 0.8)(M, H, D) * (M ** -0.5)),
            "w_uk": _w((lambda *s: torch.randn(*s, dtype=torch.bfloat16) * 0.8)(Dc, H, D) * (Dc ** -0.5)),
            "w_uv": _w((lambda *s: torch.randn(*s, dtype=torch.bfloat16) * 3.2)(Dc, H, D) * (Dc ** -0.5)),
            "w_o": _w((lambda *s: torch.randn(*s, dtype=torch.bfloat16) * 3.2)(H, D, M) * ((H * D) ** -0.5)),
        }
    _A_in = _A_setup()

    def _B_setup():
        B, S, D, F = 4, 1, 512, 1792
        return {
            "x": _w((lambda *s: torch.randn(*s, dtype=torch.bfloat16) * 0.1)(B, S, D)),
            "w1": _w((lambda *s: torch.randn(*s, dtype=torch.bfloat16) * 3.2)(D, F) * (D ** -0.5)),
            "b1": _w((lambda *s: torch.randn(*s, dtype=torch.bfloat16) * 3.2)(F) * 0.01),
            "w2": _w((lambda *s: torch.randn(*s, dtype=torch.bfloat16) * 3.2)(F, D) * (F ** -0.5)),
            "b2": _w((lambda *s: torch.randn(*s, dtype=torch.bfloat16) * 3.2)(D) * 0.01),
        }
    _B_in = _B_setup()

    return {
        "A_x": _A_in["x"],
        "A_c_kv": _A_in["c_kv"],
        "A_w_q": _A_in["w_q"],
        "A_w_uk": _A_in["w_uk"],
        "A_w_uv": _A_in["w_uv"],
        "A_w_o": _A_in["w_o"],
        "B_x": _B_in["x"],
        "B_w1": _B_in["w1"],
        "B_b1": _B_in["b1"],
        "B_w2": _B_in["w2"],
        "B_b2": _B_in["b2"],
    }

def reference(A_x, A_c_kv, A_w_q, A_w_uk, A_w_uv, A_w_o, B_x, B_w1, B_b1, B_w2, B_b2):
    def _A_ref(x, c_kv, w_q, w_uk, w_uv, w_o):
        B, Sq, M = x.shape[0], x.shape[1], x.shape[2]
        Sk = c_kv.shape[1]
        H, D = w_q.shape[1], w_q.shape[2]
        q = torch.einsum("bqm,mhd->bhqd", x, w_q)
        k = torch.einsum("bkc,chd->bhkd", c_kv, w_uk)
        v = torch.einsum("bkc,chd->bhkd", c_kv, w_uv)
        scores = torch.einsum("bhqd,bhkd->bhqk", q, k) * (D ** -0.5)
        off = Sk - Sq
        qi = torch.arange(Sq)[:, None]
        kj = torch.arange(Sk)[None, :]
        cmask = kj <= (qi + off)
        scores = torch.where(cmask[None, None], scores, -1e9)
        p = _softmax(scores, axis=-1)
        ctx = torch.einsum("bhqk,bhkd->bhqd", p, v)
        return torch.einsum("bhqd,hdm->bqm", ctx, w_o)

    def _B_ref(x, w1, b1, w2, b2):
        h = torch.einsum("bsd,df->bsf", x, w1) + b1
        h = _gelu(h)
        return torch.einsum("bsf,fd->bsd", h, w2) + b2

    x = A_x
    xn = _layernorm(x, axis=-1)
    s = _A_ref(xn, A_c_kv, A_w_q, A_w_uk, A_w_uv, A_w_o)
    g = _silu(_B_ref(xn, B_w1, B_b1, B_w2, B_b2))
    return x + s * g
```

```asm
; @launch grid=(256,1,1) block=(512,1,1) lds=163840
.amdgcn_target "amdgcn-amd-amdhsa--gfx950"
.text
.globl recurrent_scan__compressed_kv_cla__dense_activation_gelu__decode_kernel
.p2align 8
.type recurrent_scan__compressed_kv_cla__dense_activation_gelu__decode_kernel,@function
recurrent_scan__compressed_kv_cla__dense_activation_gelu__decode_kernel:
    s_cmp_ge_u32 s2, 256
    s_cbranch_scc1 L_exit
    s_load_dwordx16 s[16:31], s[0:1], 0
    s_load_dwordx8 s[32:39], s[0:1], 64
    s_load_dwordx4 s[40:43], s[0:1], 96
    v_lshrrev_b32 v1, 6, v0
    v_and_b32 v0, 63, v0
    v_readfirstlane_b32 s3, v1
    s_and_b32 s60, s2, 7
    s_lshr_b32 s61, s2, 4
    s_lshr_b32 s64, s60, 1
    s_mov_b32 s10, 0x05040100
    s_mov_b32 s11, 0x07060302
    v_and_b32 v1, 15, v0
    v_lshrrev_b32 v2, 4, v0
    v_mov_b32 v13, 0
    s_getpc_b64 s[8:9]
    s_nop 0
L_pcref:
    s_sub_u32 s8, s8, L_pcref - recurrent_scan__compressed_kv_cla__dense_activation_gelu__decode_kernel
    s_subb_u32 s9, s9, 0
    s_lshr_b32 s4, s2, 3
    s_lshl_b32 s4, s4, 3
    s_add_u32 s4, s4, s3
    s_lshl_b32 s4, s4, 7
    s_min_u32 s15, s4, L_exit - recurrent_scan__compressed_kv_cla__dense_activation_gelu__decode_kernel
    v_mov_b32 v14, s15
    global_load_dword v250, v14, s[8:9]
    s_bitcmp1_b32 s2, 3
    s_cbranch_scc0 L_A
    s_lshl_b32 s62, s60, 2
    s_and_b32 s4, s61, 3
    s_add_u32 s62, s62, s4
    s_lshr_b32 s65, s61, 2
    v_lshlrev_b32 v3, 4, v0
    v_lshlrev_b32 v5, 15, v2
    v_lshl_add_u32 v5, v1, 4, v5
    s_lshl_b32 s14, s3, 19
    s_lshl_b32 s6, s62, 8
    s_add_u32 s14, s14, s6
    s_lshl_b32 s5, s65, 17
    s_add_u32 s5, s5, s14
    s_mov_b32 m0, 8192
    s_waitcnt lgkmcnt(0)
    s_mov_b32 s48, s20
    s_and_b32 s49, s21, 0xffff
    s_mov_b32 s50, 4194304
    s_mov_b32 s51, 0x20000
    s_mov_b32 s52, s16
    s_and_b32 s53, s17, 0xffff
    s_mov_b32 s54, 4096
    s_mov_b32 s55, 0x20000
    s_cmp_lg_u32 s3, 0
    s_cbranch_scc1 L_nox
    buffer_load_dwordx4 v3, s[52:55], 0 offen offset:0 lds
    buffer_load_dwordx4 v3, s[52:55], 0 offen offset:1024 lds
    buffer_load_dwordx4 v3, s[52:55], 0 offen offset:2048 lds
    buffer_load_dwordx4 v3, s[52:55], 0 offen offset:3072 lds
L_nox:
    buffer_load_dwordx4 v[40:43], v5, s[48:51], s5 offen
    s_add_u32 s5, s5, 8192
    buffer_load_dwordx4 v[44:47], v5, s[48:51], s5 offen
    s_add_u32 s5, s5, 8192
    buffer_load_dwordx4 v[48:51], v5, s[48:51], s5 offen
    s_add_u32 s5, s5, 8192
    buffer_load_dwordx4 v[52:55], v5, s[48:51], s5 offen
    s_load_dword s12, s[42:43], 0
    s_branch L_W
L_A:
    s_and_b32 s65, s60, 1
    s_lshl_b32 s65, s65, 4
    s_add_u32 s65, s65, s61
    s_lshr_b32 s4, s61, 3
    s_lshl_b32 s4, s4, 3
    s_add_u32 s68, s60, s4
    s_and_b32 s69, s61, 7
    s_cmp_lt_u32 s68, 14
    s_cselect_b32 s70, 7, 99
    v_lshlrev_b32 v3, 4, v0
    v_xor_b32 v240, 0, v3
    v_xor_b32 v241, 32, v3
    v_xor_b32 v242, 64, v3
    v_xor_b32 v243, 96, v3
    v_xor_b32 v244, 128, v3
    v_xor_b32 v245, 160, v3
    v_xor_b32 v246, 192, v3
    v_xor_b32 v247, 224, v3
    s_lshl_b32 s4, s64, 5
    s_add_u32 s4, s4, s65
    s_lshl_b32 s4, s4, 17
    s_lshl_b32 s5, s3, 14
    s_add_u32 s4, s4, s5
    s_mov_b32 m0, s5
    s_waitcnt lgkmcnt(0)
    s_load_dword s12, s[42:43], 0
    s_mov_b32 s48, s18
    s_and_b32 s49, s19, 0xffff
    s_mov_b32 s50, 16777216
    s_mov_b32 s51, 0x20000
    s_mov_b32 s44, s42
    s_and_b32 s45, s43, 0xffff
    s_mov_b32 s46, 0x10000000
    s_mov_b32 s47, 0x20000
    s_mov_b32 s52, s22
    s_and_b32 s53, s23, 0xffff
    s_mov_b32 s54, 4194304
    s_mov_b32 s55, 0x20000
    v_lshlrev_b32 v4, 13, v2
    v_lshl_add_u32 v4, v1, 4, v4
    s_lshr_b32 s7, s61, 2
    s_lshl_b32 s7, s7, 20
    s_lshl_b32 s8, s3, 17
    s_add_u32 s7, s7, s8
    s_lshl_b32 s8, s60, 2
    s_and_b32 s9, s61, 3
    s_add_u32 s8, s8, s9
    s_lshl_b32 s8, s8, 8
    s_add_u32 s7, s7, s8
    buffer_load_dwordx4 v[176:179], v4, s[52:55], s7 offen
    s_add_u32 s7, s7, 32768
    buffer_load_dwordx4 v[180:183], v4, s[52:55], s7 offen
    s_add_u32 s7, s7, 32768
    buffer_load_dwordx4 v[184:187], v4, s[52:55], s7 offen
    s_add_u32 s7, s7, 32768
    buffer_load_dwordx4 v[188:191], v4, s[52:55], s7 offen
    s_waitcnt vmcnt(3)
    buffer_load_dwordx4 v240, s[48:51], s4 offen lds
    s_add_u32 s4, s4, 1024
    s_add_u32 m0, m0, 1024
    s_nop 0
    buffer_load_dwordx4 v241, s[48:51], s4 offen lds
    s_add_u32 s4, s4, 1024
    s_add_u32 m0, m0, 1024
    s_nop 0
    buffer_load_dwordx4 v242, s[48:51], s4 offen lds
    s_add_u32 s4, s4, 1024
    s_add_u32 m0, m0, 1024
    s_nop 0
    buffer_load_dwordx4 v243, s[48:51], s4 offen lds
    s_add_u32 s4, s4, 1024
    s_add_u32 m0, m0, 1024
    s_nop 0
    buffer_load_dwordx4 v244, s[48:51], s4 offen lds
    s_add_u32 s4, s4, 1024
    s_add_u32 m0, m0, 1024
    s_nop 0
    buffer_load_dwordx4 v245, s[48:51], s4 offen lds
    s_add_u32 s4, s4, 1024
    s_add_u32 m0, m0, 1024
    s_nop 0
    buffer_load_dwordx4 v246, s[48:51], s4 offen lds
    s_add_u32 s4, s4, 1024
    s_add_u32 m0, m0, 1024
    s_nop 0
    buffer_load_dwordx4 v247, s[48:51], s4 offen lds
    s_add_u32 s4, s4, 1024
    s_add_u32 m0, m0, 1024
    s_nop 0
    buffer_load_dwordx4 v240, s[48:51], s4 offen lds
    s_add_u32 s4, s4, 1024
    s_add_u32 m0, m0, 1024
    s_nop 0
    buffer_load_dwordx4 v241, s[48:51], s4 offen lds
    s_add_u32 s4, s4, 1024
    s_add_u32 m0, m0, 1024
    s_nop 0
    buffer_load_dwordx4 v242, s[48:51], s4 offen lds
    s_add_u32 s4, s4, 1024
    s_add_u32 m0, m0, 1024
    s_nop 0
    buffer_load_dwordx4 v243, s[48:51], s4 offen lds
    s_add_u32 s4, s4, 1024
    s_add_u32 m0, m0, 1024
    s_nop 0
    buffer_load_dwordx4 v244, s[48:51], s4 offen lds
    s_add_u32 s4, s4, 1024
    s_add_u32 m0, m0, 1024
    s_nop 0
    buffer_load_dwordx4 v245, s[48:51], s4 offen lds
    s_add_u32 s4, s4, 1024
    s_add_u32 m0, m0, 1024
    s_nop 0
    buffer_load_dwordx4 v246, s[48:51], s4 offen lds
    s_add_u32 s4, s4, 1024
    s_add_u32 m0, m0, 1024
    s_nop 0
    buffer_load_dwordx4 v247, s[48:51], s4 offen lds
    s_waitcnt lgkmcnt(0)
    s_add_u32 s12, s12, 2654435761
    s_lshl_b32 s6, s64, 15
    s_lshl_b32 s7, s3, 12
    s_add_u32 s6, s6, s7
    s_add_u32 s6, s6, 1048576
    s_add_u32 s7, s7, 131072
    s_and_b32 s4, s3, 1
    s_lshl_b32 s4, s4, 7
    v_lshlrev_b32 v15, 4, v0
    v_xor_b32 v8, s4, v15
    v_xor_b32 v9, 32, v8
    v_xor_b32 v10, 64, v8
    v_xor_b32 v11, 0x60, v8
    v_add_u32 v15, s7, v15
    v_and_b32 v3, 7, v1
    v_lshlrev_b32 v3, 1, v3
    s_lshl_b32 s4, s3, 14
    v_lshlrev_b32 v4, 10, v1
    v_add_u32 v5, 0, v2
    v_xor_b32 v5, v5, v3
    v_lshl_add_u32 v5, v5, 4, v4
    v_add_u32 v232, s4, v5
    v_add_u32 v236, 131072, v5
    v_add_u32 v5, 4, v2
    v_xor_b32 v5, v5, v3
    v_lshl_add_u32 v5, v5, 4, v4
    v_add_u32 v233, s4, v5
    v_add_u32 v237, 131072, v5
    v_add_u32 v5, 8, v2
    v_xor_b32 v5, v5, v3
    v_lshl_add_u32 v5, v5, 4, v4
    v_add_u32 v234, s4, v5
    v_add_u32 v238, 131072, v5
    v_add_u32 v5, 12, v2
    v_xor_b32 v5, v5, v3
    v_lshl_add_u32 v5, v5, 4, v4
    v_add_u32 v235, s4, v5
    v_add_u32 v239, 131072, v5
    v_lshrrev_b32 v3, 2, v1
    v_lshl_add_u32 v3, v2, 2, v3
    v_and_b32 v4, 7, v3
    v_lshlrev_b32 v3, 10, v3
    v_and_b32 v5, 3, v1
    v_lshl_add_u32 v3, v5, 3, v3
    s_lshr_b32 s4, s3, 1
    s_lshl_b32 s4, s4, 8
    v_add_u32 v3, s4, v3
    s_and_b32 s4, s3, 1
    s_lshl_b32 s4, s4, 2
    v_xor_b32 v4, s4, v4
    v_xor_b32 v6, 0, v4
    v_lshl_add_u32 v240, v6, 5, v3
    v_add_u32 v244, 0x10000, v240
    v_xor_b32 v6, 1, v4
    v_lshl_add_u32 v241, v6, 5, v3
    v_add_u32 v245, 0x10000, v241
    v_xor_b32 v6, 2, v4
    v_lshl_add_u32 v242, v6, 5, v3
    v_add_u32 v246, 0x10000, v242
    v_xor_b32 v6, 3, v4
    v_lshl_add_u32 v243, v6, 5, v3
    v_add_u32 v247, 0x10000, v243
    s_add_u32 s4, s12, 0
    v_mov_b32 v7, s4
    v_and_b32 v224, 1, v7
    v_bfe_u32 v4, v7, 1, 1
    v_lshl_or_b32 v224, v4, 16, v224
    s_add_u32 s4, s12, 1
    v_mov_b32 v7, s4
    v_and_b32 v225, 1, v7
    v_bfe_u32 v4, v7, 1, 1
    v_lshl_or_b32 v225, v4, 16, v225
    s_add_u32 s4, s12, 2
    v_mov_b32 v7, s4
    v_and_b32 v226, 1, v7
    v_bfe_u32 v4, v7, 1, 1
    v_lshl_or_b32 v226, v4, 16, v226
    s_add_u32 s4, s12, 3
    v_mov_b32 v7, s4
    v_and_b32 v227, 1, v7
    v_bfe_u32 v4, v7, 1, 1
    v_lshl_or_b32 v227, v4, 16, v227
    v_mov_b32 v252, 0xfffefffe
    v_lshlrev_b32 v6, 5, v1
    s_lshl_b32 s4, s3, 2
    s_add_u32 s4, s4, 139264
    v_add_u32 v5, s4, v6
    v_add_u32 v6, 139264, v6
    v_and_b32 v7, 1, v2
    v_lshl_add_u32 v5, v7, 9, v5
    s_lshr_b32 s4, s3, 1
    s_lshl_b32 s4, s4, 11
    s_and_b32 s5, s3, 1
    s_lshl_b32 s5, s5, 3
    s_add_u32 s4, s4, s5
    s_add_u32 s4, s4, 131072
    v_lshlrev_b32 v12, 4, v0
    v_add_u32 v7, s4, v12
    v_add_u32 v12, 131072, v12
    s_mov_b32 s4, 524288
    v_mul_lo_u32 v253, v2, s4
    v_lshrrev_b32 v3, 3, v1
    v_cmp_eq_u32 vcc, 1, v3
    v_lshl_add_u32 v253, v3, 17, v253
    v_and_b32 v3, 7, v1
    v_lshl_add_u32 v253, v3, 4, v253
    v_cndmask_b32 v254, v224, v226, vcc
    v_cndmask_b32 v255, v225, v227, vcc
    s_lshl_b32 s14, s64, 15
    s_lshl_b32 s4, s3, 12
    s_add_u32 s14, s14, s4
    s_lshl_b32 s4, s65, 7
    s_add_u32 s14, s14, s4
    s_add_u32 s14, s14, 2097152
    v_mov_b32 v228, 0x3f803f80
    v_mov_b32 v229, 0x3f803f80
    v_mov_b32 v230, 0x3f803f80
    v_mov_b32 v231, 0x3f803f80
    v_mov_b32 v251, s12
    v_lshlrev_b32 v13, 4, v1
    s_lshl_b32 s15, s3, 8
    s_lshl_b32 s4, s64, 14
    s_add_u32 s15, s15, s4
    s_lshl_b32 s4, s65, 9
    s_add_u32 s15, s15, s4
    s_add_u32 s15, s15, 655360
    s_mov_b32 s71, 0x3e0293ee
    s_barrier
    s_mov_b32 m0, s7
    s_nop 0
    buffer_load_dwordx4 v8, s[44:47], s6 offen offset:0 sc1 lds
    buffer_load_dwordx4 v9, s[44:47], s6 offen offset:1024 sc1 lds
    buffer_load_dwordx4 v10, s[44:47], s6 offen offset:2048 sc1 lds
    buffer_load_dwordx4 v11, s[44:47], s6 offen offset:3072 sc1 lds
    s_waitcnt vmcnt(4)
    ds_read_b128 v[16:19], v232 offset:0
    ds_read_b128 v[20:23], v233 offset:0
    ds_read_b128 v[24:27], v234 offset:0
    ds_read_b128 v[28:31], v235 offset:0
    ds_read_b128 v[32:35], v232 offset:256
    ds_read_b128 v[36:39], v233 offset:256
    ds_read_b128 v[40:43], v234 offset:256
    ds_read_b128 v[44:47], v235 offset:256
    ds_read_b128 v[48:51], v232 offset:512
    ds_read_b128 v[52:55], v233 offset:512
    ds_read_b128 v[56:59], v234 offset:512
    ds_read_b128 v[60:63], v235 offset:512
    ds_read_b128 v[64:67], v232 offset:768
    ds_read_b128 v[68:71], v233 offset:768
    ds_read_b128 v[72:75], v234 offset:768
    ds_read_b128 v[76:79], v235 offset:768
    s_mov_b32 s13, 0
    s_waitcnt vmcnt(0)
    s_branch L_chk2
L_poll1:
    s_mov_b32 m0, s7
    s_nop 0
    buffer_load_dwordx4 v8, s[44:47], s6 offen offset:0 sc1 lds
    buffer_load_dwordx4 v9, s[44:47], s6 offen offset:1024 sc1 lds
    buffer_load_dwordx4 v10, s[44:47], s6 offen offset:2048 sc1 lds
    buffer_load_dwordx4 v11, s[44:47], s6 offen offset:3072 sc1 lds
    s_waitcnt vmcnt(0)
L_chk2:
    s_mov_b64 s[8:9], exec
    s_mov_b64 exec, -1
    ds_read_b128 v[208:211], v15 offset:0
    ds_read_b128 v[212:215], v15 offset:1024
    ds_read_b128 v[216:219], v15 offset:2048
    ds_read_b128 v[220:223], v15 offset:3072
    s_waitcnt lgkmcnt(0)
    v_xor_b32 v14, v208, v224
    v_bitop3_b32 v14, v14, v209, v225 bitop3:0xf6
    v_bitop3_b32 v14, v14, v210, v226 bitop3:0xf6
    v_bitop3_b32 v14, v14, v211, v227 bitop3:0xf6
    v_bitop3_b32 v14, v14, v212, v224 bitop3:0xf6
    v_bitop3_b32 v14, v14, v213, v225 bitop3:0xf6
    v_bitop3_b32 v14, v14, v214, v226 bitop3:0xf6
    v_bitop3_b32 v14, v14, v215, v227 bitop3:0xf6
    v_bitop3_b32 v14, v14, v216, v224 bitop3:0xf6
    v_bitop3_b32 v14, v14, v217, v225 bitop3:0xf6
    v_bitop3_b32 v14, v14, v218, v226 bitop3:0xf6
    v_bitop3_b32 v14, v14, v219, v227 bitop3:0xf6
    v_bitop3_b32 v14, v14, v220, v224 bitop3:0xf6
    v_bitop3_b32 v14, v14, v221, v225 bitop3:0xf6
    v_bitop3_b32 v14, v14, v222, v226 bitop3:0xf6
    v_bitop3_b32 v14, v14, v223, v227 bitop3:0xf6
    v_and_b32 v14, 0x00010001, v14
    s_nop 1
    v_or_b32_dpp v14, v14, v14 quad_perm:[1,0,3,2] row_mask:0xf bank_mask:0xf
    s_nop 1
    v_or_b32_dpp v14, v14, v14 quad_perm:[2,3,0,1] row_mask:0xf bank_mask:0xf
    s_nop 1
    v_or_b32_dpp v14, v14, v14 row_half_mirror row_mask:0xf bank_mask:0xf
    v_cmp_ne_u32 vcc, 0, v14
    s_nop 3
    s_cbranch_vccz L_done3
    s_mov_b64 exec, vcc
    s_add_u32 s13, s13, 1
    s_cmp_ge_u32 s13, 100000
    s_cbranch_scc1 L_done3
    s_sleep 3
    s_branch L_poll1
L_done3:
    s_mov_b64 exec, -1
    s_barrier
    ds_read_b128 v[80:83], v236 offset:0
    ds_read_b128 v[84:87], v236 offset:16384
    ds_read_b128 v[88:91], v237 offset:0
    ds_read_b128 v[92:95], v237 offset:16384
    ds_read_b128 v[96:99], v238 offset:0
    ds_read_b128 v[100:103], v238 offset:16384
    ds_read_b128 v[104:107], v239 offset:0
    ds_read_b128 v[108:111], v239 offset:16384
    ds_read_b128 v[112:115], v236 offset:256
    ds_read_b128 v[116:119], v236 offset:16640
    ds_read_b128 v[120:123], v237 offset:256
    ds_read_b128 v[124:127], v237 offset:16640
    ds_read_b128 v[128:131], v238 offset:256
    ds_read_b128 v[132:135], v238 offset:16640
    s_waitcnt lgkmcnt(13)
    v_mfma_f32_16x16x32_bf16 v[136:139], v[16:19], v[80:83], 0
    ds_read_b128 v[80:83], v239 offset:256
    s_waitcnt lgkmcnt(12)
    v_mfma_f32_16x16x32_bf16 v[140:143], v[16:19], v[84:87], 0
    ds_read_b128 v[84:87], v239 offset:16640
    v_mfma_f32_16x16x32_bf16 v[136:139], v[20:23], v[88:91], v[136:139]
    ds_read_b128 v[88:91], v236 offset:512
    s_waitcnt lgkmcnt(12)
    v_mfma_f32_16x16x32_bf16 v[140:143], v[20:23], v[92:95], v[140:143]
    ds_read_b128 v[92:95], v236 offset:16896
    v_mfma_f32_16x16x32_bf16 v[136:139], v[24:27], v[96:99], v[136:139]
    ds_read_b128 v[96:99], v237 offset:512
    s_waitcnt lgkmcnt(12)
    v_mfma_f32_16x16x32_bf16 v[140:143], v[24:27], v[100:103], v[140:143]
    ds_read_b128 v[100:103], v237 offset:16896
    v_mfma_f32_16x16x32_bf16 v[136:139], v[28:31], v[104:107], v[136:139]
    ds_read_b128 v[104:107], v238 offset:512
    s_waitcnt lgkmcnt(12)
    v_mfma_f32_16x16x32_bf16 v[140:143], v[28:31], v[108:111], v[140:143]
    ds_read_b128 v[108:111], v238 offset:16896
    v_mfma_f32_16x16x32_bf16 v[136:139], v[32:35], v[112:115], v[136:139]
    ds_read_b128 v[112:115], v239 offset:512
    s_waitcnt lgkmcnt(12)
    v_mfma_f32_16x16x32_bf16 v[140:143], v[32:35], v[116:119], v[140:143]
    ds_read_b128 v[116:119], v239 offset:16896
    v_mfma_f32_16x16x32_bf16 v[136:139], v[36:39], v[120:123], v[136:139]
    ds_read_b128 v[120:123], v236 offset:768
    s_waitcnt lgkmcnt(12)
    v_mfma_f32_16x16x32_bf16 v[140:143], v[36:39], v[124:127], v[140:143]
    ds_read_b128 v[124:127], v236 offset:17152
    v_mfma_f32_16x16x32_bf16 v[136:139], v[40:43], v[128:131], v[136:139]
    ds_read_b128 v[128:131], v237 offset:768
    s_waitcnt lgkmcnt(12)
    v_mfma_f32_16x16x32_bf16 v[140:143], v[40:43], v[132:135], v[140:143]
    ds_read_b128 v[132:135], v237 offset:17152
    v_mfma_f32_16x16x32_bf16 v[136:139], v[44:47], v[80:83], v[136:139]
    ds_read_b128 v[80:83], v238 offset:768
    s_waitcnt lgkmcnt(12)
    v_mfma_f32_16x16x32_bf16 v[140:143], v[44:47], v[84:87], v[140:143]
    ds_read_b128 v[84:87], v238 offset:17152
    v_mfma_f32_16x16x32_bf16 v[136:139], v[48:51], v[88:91], v[136:139]
    ds_read_b128 v[88:91], v239 offset:768
    s_waitcnt lgkmcnt(12)
    v_mfma_f32_16x16x32_bf16 v[140:143], v[48:51], v[92:95], v[140:143]
    ds_read_b128 v[92:95], v239 offset:17152
    v_mfma_f32_16x16x32_bf16 v[136:139], v[52:55], v[96:99], v[136:139]
    s_waitcnt lgkmcnt(11)
    v_mfma_f32_16x16x32_bf16 v[140:143], v[52:55], v[100:103], v[140:143]
    v_mfma_f32_16x16x32_bf16 v[136:139], v[56:59], v[104:107], v[136:139]
    s_waitcnt lgkmcnt(9)
    v_mfma_f32_16x16x32_bf16 v[140:143], v[56:59], v[108:111], v[140:143]
    v_mfma_f32_16x16x32_bf16 v[136:139], v[60:63], v[112:115], v[136:139]
    s_waitcnt lgkmcnt(7)
    v_mfma_f32_16x16x32_bf16 v[140:143], v[60:63], v[116:119], v[140:143]
    v_mfma_f32_16x16x32_bf16 v[136:139], v[64:67], v[120:123], v[136:139]
    s_waitcnt lgkmcnt(5)
    v_mfma_f32_16x16x32_bf16 v[140:143], v[64:67], v[124:127], v[140:143]
    v_mfma_f32_16x16x32_bf16 v[136:139], v[68:71], v[128:131], v[136:139]
    s_waitcnt lgkmcnt(3)
    v_mfma_f32_16x16x32_bf16 v[140:143], v[68:71], v[132:135], v[140:143]
    v_mfma_f32_16x16x32_bf16 v[136:139], v[72:75], v[80:83], v[136:139]
    s_waitcnt lgkmcnt(1)
    v_mfma_f32_16x16x32_bf16 v[140:143], v[72:75], v[84:87], v[140:143]
    v_mfma_f32_16x16x32_bf16 v[136:139], v[76:79], v[88:91], v[136:139]
    s_waitcnt lgkmcnt(0)
    s_barrier
    v_mfma_f32_16x16x32_bf16 v[140:143], v[76:79], v[92:95], v[140:143]
    s_nop 4
    v_max3_f32 v3, v136, v137, v138
    v_max_f32 v3, v3, v139
    s_nop 0
    v_max3_f32 v8, v140, v141, v142
    v_max_f32 v8, v8, v143
    s_nop 1
    v_permlane16_swap_b32 v3, v8
    v_max_f32 v3, v3, v8
    v_mov_b32 v4, v3
    s_nop 1
    v_permlane32_swap_b32 v3, v4
    v_max_f32 v3, v3, v4
    ds_write_b32 v5, v3
    ds_read_b64_tr_b16 v[16:17], v240 offset:0
    ds_read_b64_tr_b16 v[18:19], v240 offset:16384
    ds_read_b64_tr_b16 v[20:21], v241 offset:0
    ds_read_b64_tr_b16 v[22:23], v241 offset:16384
    s_waitcnt lgkmcnt(4)
    s_barrier
    ds_read_b128 v[80:83], v6 offset:0
    ds_read_b128 v[84:87], v6 offset:16
    ds_read_b128 v[88:91], v6 offset:512
    ds_read_b128 v[92:95], v6 offset:528
    s_waitcnt lgkmcnt(2)
    v_max3_f32 v80, v80, v81, v82
    v_max3_f32 v83, v83, v84, v85
    v_max3_f32 v80, v80, v86, v87
    s_waitcnt lgkmcnt(0)
    v_max3_f32 v88, v88, v89, v90
    v_max_f32 v80, v80, v83
    v_max3_f32 v91, v91, v92, v93
    v_mul_f32 v248, s71, v80
    v_max3_f32 v88, v88, v94, v95
    v_fma_f32 v136, v136, s71, -v248
    v_fma_f32 v137, v137, s71, -v248
    v_fma_f32 v138, v138, s71, -v248
    v_fma_f32 v139, v139, s71, -v248
    v_max_f32 v88, v88, v91
    v_exp_f32 v136, v136
    v_exp_f32 v137, v137
    v_exp_f32 v138, v138
    v_exp_f32 v139, v139
    v_mul_f32 v249, s71, v88
    v_fma_f32 v140, v140, s71, -v249
    v_fma_f32 v141, v141, s71, -v249
    v_fma_f32 v142, v142, s71, -v249
    v_fma_f32 v143, v143, s71, -v249
    v_cvt_pk_bf16_f32 v96, v136, v137
    v_cvt_pk_bf16_f32 v97, v138, v139
    v_exp_f32 v140, v140
    v_exp_f32 v141, v141
    v_exp_f32 v142, v142
    v_exp_f32 v143, v143
    ds_write_b64 v7, v[96:97]
    v_cvt_pk_bf16_f32 v98, v140, v141
    v_cvt_pk_bf16_f32 v99, v142, v143
    ds_write_b64 v7, v[98:99] offset:1024
    ds_read_b64_tr_b16 v[24:25], v242 offset:0
    ds_read_b64_tr_b16 v[26:27], v242 offset:16384
    ds_read_b64_tr_b16 v[28:29], v243 offset:0
    ds_read_b64_tr_b16 v[30:31], v243 offset:16384
    ds_read_b64_tr_b16 v[32:33], v240 offset:32768
    ds_read_b64_tr_b16 v[34:35], v240 offset:49152
    ds_read_b64_tr_b16 v[36:37], v241 offset:32768
    ds_read_b64_tr_b16 v[38:39], v241 offset:49152
    s_waitcnt lgkmcnt(8)
    s_barrier
    s_cmp_ge_u32 s3, 2
    s_cbranch_scc1 L_nohs0
    s_lshl_b32 s4, s3, 10
    v_add_u32 v3, s4, v12
    ds_read_b128 v[112:115], v3 offset:0
    ds_read_b128 v[116:119], v3 offset:2048
    ds_read_b128 v[120:123], v3 offset:4096
    ds_read_b128 v[124:127], v3 offset:6144
    s_cmp_eq_u32 s3, 0
    s_cbranch_scc1 L_hs00
    v_mov_b32 v248, v249
    s_nop 1
L_hs00:
    s_waitcnt lgkmcnt(3)
    v_mfma_f32_16x16x32_bf16 v[208:211], v[228:231], v[112:115], 0
    s_waitcnt lgkmcnt(2)
    v_mfma_f32_16x16x32_bf16 v[208:211], v[228:231], v[116:119], v[208:211]
    s_waitcnt lgkmcnt(1)
    v_mfma_f32_16x16x32_bf16 v[208:211], v[228:231], v[120:123], v[208:211]
    s_waitcnt lgkmcnt(0)
    v_mfma_f32_16x16x32_bf16 v[208:211], v[228:231], v[124:127], v[208:211]
    s_nop 7
    v_mov_b32 v249, v208
    s_mov_b64 exec, 0xffff
    buffer_store_dwordx4 v[248:251], v13, s[44:47], s15 offen sc1
    s_mov_b64 exec, -1
    s_nop 0
L_nohs0:
    ds_read_b128 v[80:83], v12 offset:0
    ds_read_b128 v[88:91], v12 offset:2048
    ds_read_b128 v[96:99], v12 offset:4096
    ds_read_b128 v[104:107], v12 offset:6144
    s_waitcnt lgkmcnt(3)
    v_mfma_f32_16x16x32_bf16 v[144:147], v[80:83], v[16:19], 0
    ds_read_b64_tr_b16 v[40:41], v242 offset:32768
    ds_read_b64_tr_b16 v[42:43], v242 offset:49152
    v_mfma_f32_16x16x32_bf16 v[148:151], v[80:83], v[20:23], 0
    ds_read_b64_tr_b16 v[44:45], v243 offset:32768
    ds_read_b64_tr_b16 v[46:47], v243 offset:49152
    v_mfma_f32_16x16x32_bf16 v[152:155], v[80:83], v[24:27], 0
    ds_read_b64_tr_b16 v[48:49], v244 offset:0
    ds_read_b64_tr_b16 v[50:51], v244 offset:16384
    v_mfma_f32_16x16x32_bf16 v[156:159], v[80:83], v[28:31], 0
    ds_read_b64_tr_b16 v[52:53], v245 offset:0
    ds_read_b64_tr_b16 v[54:55], v245 offset:16384
    s_waitcnt lgkmcnt(10)
    v_mfma_f32_16x16x32_bf16 v[144:147], v[88:91], v[32:35], v[144:147]
    ds_read_b64_tr_b16 v[56:57], v246 offset:0
    ds_read_b64_tr_b16 v[58:59], v246 offset:16384
    v_mfma_f32_16x16x32_bf16 v[148:151], v[88:91], v[36:39], v[148:151]
    ds_read_b64_tr_b16 v[60:61], v247 offset:0
    ds_read_b64_tr_b16 v[62:63], v247 offset:16384
    s_waitcnt lgkmcnt(8)
    v_mfma_f32_16x16x32_bf16 v[152:155], v[88:91], v[40:43], v[152:155]
    ds_read_b64_tr_b16 v[64:65], v244 offset:32768
    ds_read_b64_tr_b16 v[66:67], v244 offset:49152
    v_mfma_f32_16x16x32_bf16 v[156:159], v[88:91], v[44:47], v[156:159]
    ds_read_b64_tr_b16 v[68:69], v245 offset:32768
    ds_read_b64_tr_b16 v[70:71], v245 offset:49152
    ds_read_b128 v[84:87], v12 offset:1024
    ds_read_b128 v[92:95], v12 offset:3072
    s_waitcnt lgkmcnt(10)
    v_mfma_f32_16x16x32_bf16 v[144:147], v[96:99], v[48:51], v[144:147]
    ds_read_b64_tr_b16 v[72:73], v246 offset:32768
    ds_read_b64_tr_b16 v[74:75], v246 offset:49152
    v_mfma_f32_16x16x32_bf16 v[148:151], v[96:99], v[52:55], v[148:151]
    ds_read_b64_tr_b16 v[76:77], v247 offset:32768
    ds_read_b64_tr_b16 v[78:79], v247 offset:49152
    s_waitcnt lgkmcnt(10)
    v_mfma_f32_16x16x32_bf16 v[152:155], v[96:99], v[56:59], v[152:155]
    v_mfma_f32_16x16x32_bf16 v[156:159], v[96:99], v[60:63], v[156:159]
    ds_read_b128 v[100:103], v12 offset:5120
    ds_read_b128 v[108:111], v12 offset:7168
    s_waitcnt lgkmcnt(8)
    v_mfma_f32_16x16x32_bf16 v[144:147], v[104:107], v[64:67], v[144:147]
    v_mfma_f32_16x16x32_bf16 v[148:151], v[104:107], v[68:71], v[148:151]
    s_waitcnt lgkmcnt(2)
    v_mfma_f32_16x16x32_bf16 v[152:155], v[104:107], v[72:75], v[152:155]
    v_mfma_f32_16x16x32_bf16 v[156:159], v[104:107], v[76:79], v[156:159]
    v_mfma_f32_16x16x32_bf16 v[160:163], v[84:87], v[16:19], 0
    v_mfma_f32_16x16x32_bf16 v[164:167], v[84:87], v[20:23], 0
    v_mfma_f32_16x16x32_bf16 v[168:171], v[84:87], v[24:27], 0
    v_mfma_f32_16x16x32_bf16 v[172:175], v[84:87], v[28:31], 0
    v_mfma_f32_16x16x32_bf16 v[160:163], v[92:95], v[32:35], v[160:163]
    v_cvt_pk_bf16_f32 v176, v144, v148
    s_nop 1
    v_cvt_pk_bf16_f32 v177, v152, v156
    v_mfma_f32_16x16x32_bf16 v[164:167], v[92:95], v[36:39], v[164:167]
    v_cvt_pk_bf16_f32 v178, v145, v149
    v_cvt_pk_bf16_f32 v179, v153, v157
    v_mfma_f32_16x16x32_bf16 v[168:171], v[92:95], v[40:43], v[168:171]
    v_cvt_pk_bf16_f32 v180, v146, v150
    v_cvt_pk_bf16_f32 v181, v154, v158
    v_mfma_f32_16x16x32_bf16 v[172:175], v[92:95], v[44:47], v[172:175]
    v_cvt_pk_bf16_f32 v182, v147, v151
    v_cvt_pk_bf16_f32 v183, v155, v159
    s_waitcnt lgkmcnt(1)
    v_mfma_f32_16x16x32_bf16 v[160:163], v[100:103], v[48:51], v[160:163]
    v_and_or_b32 v176, v176, v252, v254
    v_and_or_b32 v177, v177, v252, v255
    v_mfma_f32_16x16x32_bf16 v[164:167], v[100:103], v[52:55], v[164:167]
    v_and_or_b32 v178, v178, v252, v254
    v_and_or_b32 v179, v179, v252, v255
    v_mfma_f32_16x16x32_bf16 v[168:171], v[100:103], v[56:59], v[168:171]
    v_and_or_b32 v180, v180, v252, v254
    v_and_or_b32 v181, v181, v252, v255
    v_mfma_f32_16x16x32_bf16 v[172:175], v[100:103], v[60:63], v[172:175]
    v_and_or_b32 v182, v182, v252, v254
    v_and_or_b32 v183, v183, v252, v255
    s_waitcnt lgkmcnt(0)
    v_mfma_f32_16x16x32_bf16 v[160:163], v[108:111], v[64:67], v[160:163]
    v_mov_b32_dpp v192, v176 row_ror:8 row_mask:0xf bank_mask:0xf
    v_mov_b32_dpp v193, v177 row_ror:8 row_mask:0xf bank_mask:0xf
    v_mfma_f32_16x16x32_bf16 v[164:167], v[108:111], v[68:71], v[164:167]
    v_mov_b32_dpp v194, v180 row_ror:8 row_mask:0xf bank_mask:0xf
    v_mov_b32_dpp v195, v181 row_ror:8 row_mask:0xf bank_mask:0xf
    v_mfma_f32_16x16x32_bf16 v[168:171], v[108:111], v[72:75], v[168:171]
    v_mov_b32_dpp v176, v178 row_ror:8 row_mask:0xf bank_mask:0xc
    v_mov_b32_dpp v177, v179 row_ror:8 row_mask:0xf bank_mask:0xc
    v_mfma_f32_16x16x32_bf16 v[172:175], v[108:111], v[76:79], v[172:175]
    v_mov_b32_dpp v180, v182 row_ror:8 row_mask:0xf bank_mask:0xc
    v_mov_b32_dpp v181, v183 row_ror:8 row_mask:0xf bank_mask:0xc
    v_mov_b32_dpp v178, v192 quad_perm:[0,1,2,3] row_mask:0xf bank_mask:0x3
    v_mov_b32_dpp v179, v193 quad_perm:[0,1,2,3] row_mask:0xf bank_mask:0x3
    buffer_store_dwordx4 v[176:179], v253, s[44:47], s14 offen sc1
    s_add_u32 s14, s14, 262144
    v_mov_b32_dpp v182, v194 quad_perm:[0,1,2,3] row_mask:0xf bank_mask:0x3
    v_mov_b32_dpp v183, v195 quad_perm:[0,1,2,3] row_mask:0xf bank_mask:0x3
    buffer_store_dwordx4 v[180:183], v253, s[44:47], s14 offen sc1
    s_add_u32 s14, s14, 1835008
    v_cvt_pk_bf16_f32 v184, v160, v164
    v_cvt_pk_bf16_f32 v185, v168, v172
    v_cvt_pk_bf16_f32 v186, v161, v165
    v_cvt_pk_bf16_f32 v187, v169, v173
    v_cvt_pk_bf16_f32 v188, v162, v166
    v_cvt_pk_bf16_f32 v189, v170, v174
    v_cvt_pk_bf16_f32 v190, v163, v167
    v_cvt_pk_bf16_f32 v191, v171, v175
    v_and_or_b32 v184, v184, v252, v254
    v_and_or_b32 v185, v185, v252, v255
    v_and_or_b32 v186, v186, v252, v254
    v_and_or_b32 v187, v187, v252, v255
    v_and_or_b32 v188, v188, v252, v254
    v_and_or_b32 v189, v189, v252, v255
    v_and_or_b32 v190, v190, v252, v254
    v_and_or_b32 v191, v191, v252, v255
    v_mov_b32_dpp v192, v184 row_ror:8 row_mask:0xf bank_mask:0xf
    v_mov_b32_dpp v193, v185 row_ror:8 row_mask:0xf bank_mask:0xf
    v_mov_b32_dpp v194, v188 row_ror:8 row_mask:0xf bank_mask:0xf
    v_mov_b32_dpp v195, v189 row_ror:8 row_mask:0xf bank_mask:0xf
    v_mov_b32_dpp v184, v186 row_ror:8 row_mask:0xf bank_mask:0xc
    v_mov_b32_dpp v185, v187 row_ror:8 row_mask:0xf bank_mask:0xc
    v_mov_b32_dpp v188, v190 row_ror:8 row_mask:0xf bank_mask:0xc
    v_mov_b32_dpp v189, v191 row_ror:8 row_mask:0xf bank_mask:0xc
    v_mov_b32_dpp v186, v192 quad_perm:[0,1,2,3] row_mask:0xf bank_mask:0x3
    v_mov_b32_dpp v187, v193 quad_perm:[0,1,2,3] row_mask:0xf bank_mask:0x3
    buffer_store_dwordx4 v[184:187], v253, s[44:47], s14 offen sc1
    s_add_u32 s14, s14, 262144
    v_mov_b32_dpp v190, v194 quad_perm:[0,1,2,3] row_mask:0xf bank_mask:0x3
    v_mov_b32_dpp v191, v195 quad_perm:[0,1,2,3] row_mask:0xf bank_mask:0x3
    buffer_store_dwordx4 v[188:191], v253, s[44:47], s14 offen sc1
    s_cmp_eq_u32 s3, s70
    s_cbranch_scc1 L_mlp2
    s_endpgm
L_mlp2:
    s_mov_b32 s48, s34
    s_and_b32 s49, s35, 0xffff
    s_mov_b32 s50, 1835008
    s_mov_b32 s51, 0x20000
    s_mov_b32 s52, s32
    s_and_b32 s53, s33, 0xffff
    s_mov_b32 s54, 3584
    s_mov_b32 s55, 0x20000
    v_lshrrev_b32 v13, 2, v1
    v_mul_u32_u24 v13, 1536, v13
    v_lshl_add_u32 v13, v2, 6, v13
    v_and_b32 v14, 3, v1
    v_lshl_add_u32 v13, v14, 4, v13
    s_mul_i32 s66, s68, 12288
    s_add_u32 s66, s66, 458752
    s_add_u32 s67, s66, 6144
    s_mov_b32 s10, 0x05040100
    s_mov_b32 s11, 0x07060302
    v_lshrrev_b32 v6, 2, v1
    v_lshlrev_b32 v6, 4, v6
    v_lshl_add_u32 v6, v2, 6, v6
    s_lshl_b32 s5, s68, 8
    buffer_load_dwordx4 v[16:19], v13, s[44:47], s66 offen offset:0 sc1
    buffer_load_dwordx4 v[20:23], v13, s[44:47], s66 offen offset:256 sc1
    buffer_load_dwordx4 v[24:27], v13, s[44:47], s66 offen offset:512 sc1
    buffer_load_dwordx4 v[28:31], v13, s[44:47], s66 offen offset:768 sc1
    buffer_load_dwordx4 v[32:35], v13, s[44:47], s66 offen offset:1024 sc1
    buffer_load_dwordx4 v[36:39], v13, s[44:47], s66 offen offset:1280 sc1
    buffer_load_dwordx4 v[40:43], v13, s[44:47], s67 offen offset:0 sc1
    buffer_load_dwordx4 v[44:47], v13, s[44:47], s67 offen offset:256 sc1
    buffer_load_dwordx4 v[48:51], v13, s[44:47], s67 offen offset:512 sc1
    buffer_load_dwordx4 v[52:55], v13, s[44:47], s67 offen offset:768 sc1
    buffer_load_dwordx4 v[56:59], v13, s[44:47], s67 offen offset:1024 sc1
    buffer_load_dwordx4 v[60:63], v13, s[44:47], s67 offen offset:1280 sc1
    buffer_load_dwordx4 v[64:67], v6, s[52:55], s5 offen
    s_lshl_b32 s5, s68, 17
    s_lshl_b32 s4, s69, 7
    s_add_u32 s5, s5, s4
    v_lshrrev_b32 v5, 3, v0
    v_lshlrev_b32 v5, 10, v5
    v_and_b32 v6, 7, v0
    v_lshlrev_b32 v7, 1, v2
    v_xor_b32 v6, v6, v7
    v_lshl_add_u32 v5, v6, 4, v5
    s_mov_b32 m0, 143360
    s_nop 0
    buffer_load_dwordx4 v5, s[48:51], s5 offen lds
    s_add_u32 s5, s5, 8192
    s_add_u32 m0, m0, 1024
    s_nop 0
    buffer_load_dwordx4 v5, s[48:51], s5 offen lds
    s_add_u32 s5, s5, 8192
    s_add_u32 m0, m0, 1024
    s_nop 0
    buffer_load_dwordx4 v5, s[48:51], s5 offen lds
    s_add_u32 s5, s5, 8192
    s_add_u32 m0, m0, 1024
    s_nop 0
    buffer_load_dwordx4 v5, s[48:51], s5 offen lds
    s_add_u32 s5, s5, 8192
    s_add_u32 m0, m0, 1024
    s_nop 0
    buffer_load_dwordx4 v5, s[48:51], s5 offen lds
    s_add_u32 s5, s5, 8192
    s_add_u32 m0, m0, 1024
    s_nop 0
    buffer_load_dwordx4 v5, s[48:51], s5 offen lds
    s_add_u32 s5, s5, 8192
    s_add_u32 m0, m0, 1024
    s_nop 0
    buffer_load_dwordx4 v5, s[48:51], s5 offen lds
    s_add_u32 s5, s5, 8192
    s_add_u32 m0, m0, 1024
    s_nop 0
    buffer_load_dwordx4 v5, s[48:51], s5 offen lds
    s_add_u32 s5, s5, 8192
    s_add_u32 m0, m0, 1024
    s_nop 0
    buffer_load_dwordx4 v5, s[48:51], s5 offen lds
    s_add_u32 s5, s5, 8192
    s_add_u32 m0, m0, 1024
    s_nop 0
    buffer_load_dwordx4 v5, s[48:51], s5 offen lds
    s_add_u32 s5, s5, 8192
    s_add_u32 m0, m0, 1024
    s_nop 0
    buffer_load_dwordx4 v5, s[48:51], s5 offen lds
    s_add_u32 s5, s5, 8192
    s_add_u32 m0, m0, 1024
    s_nop 0
    buffer_load_dwordx4 v5, s[48:51], s5 offen lds
    s_add_u32 s5, s5, 8192
    s_add_u32 m0, m0, 1024
    s_nop 0
    buffer_load_dwordx4 v5, s[48:51], s5 offen lds
    s_add_u32 s5, s5, 8192
    s_add_u32 m0, m0, 1024
    s_nop 0
    buffer_load_dwordx4 v5, s[48:51], s5 offen lds
    s_add_u32 s5, s5, 8192
    s_add_u32 m0, m0, 1024
    s_nop 0
    buffer_load_dwordx4 v5, s[48:51], s5 offen lds
    s_add_u32 s5, s5, 8192
    s_add_u32 m0, m0, 1024
    s_nop 0
    buffer_load_dwordx4 v5, s[48:51], s5 offen lds
    v_lshrrev_b32 v3, 2, v1
    v_lshrrev_b32 v4, 3, v1
    v_lshlrev_b32 v4, 1, v4
    v_lshlrev_b32 v3, 7, v3
    v_lshl_add_u32 v3, v2, 12, v3
    v_and_b32 v5, 1, v1
    v_lshl_add_u32 v3, v5, 3, v3
    v_add_u32 v3, 143360, v3
    v_bfe_u32 v5, v1, 1, 1
    v_add_u32 v6, 0, v5
    v_xor_b32 v6, v6, v4
    v_lshl_add_u32 v68, v6, 4, v3
    v_add_u32 v6, 2, v5
    v_xor_b32 v6, v6, v4
    v_lshl_add_u32 v69, v6, 4, v3
    v_add_u32 v6, 4, v5
    v_xor_b32 v6, v6, v4
    v_lshl_add_u32 v70, v6, 4, v3
    v_add_u32 v6, 6, v5
    v_xor_b32 v6, v6, v4
    v_lshl_add_u32 v71, v6, 4, v3
    s_mov_b32 s13, 0
    s_waitcnt vmcnt(16)
    s_branch L_chk5
L_poll4:
    buffer_load_dwordx4 v[16:19], v13, s[44:47], s66 offen offset:0 sc1
    buffer_load_dwordx4 v[20:23], v13, s[44:47], s66 offen offset:256 sc1
    buffer_load_dwordx4 v[24:27], v13, s[44:47], s66 offen offset:512 sc1
    buffer_load_dwordx4 v[28:31], v13, s[44:47], s66 offen offset:768 sc1
    buffer_load_dwordx4 v[32:35], v13, s[44:47], s66 offen offset:1024 sc1
    buffer_load_dwordx4 v[36:39], v13, s[44:47], s66 offen offset:1280 sc1
    buffer_load_dwordx4 v[40:43], v13, s[44:47], s67 offen offset:0 sc1
    buffer_load_dwordx4 v[44:47], v13, s[44:47], s67 offen offset:256 sc1
    buffer_load_dwordx4 v[48:51], v13, s[44:47], s67 offen offset:512 sc1
    buffer_load_dwordx4 v[52:55], v13, s[44:47], s67 offen offset:768 sc1
    buffer_load_dwordx4 v[56:59], v13, s[44:47], s67 offen offset:1024 sc1
    buffer_load_dwordx4 v[60:63], v13, s[44:47], s67 offen offset:1280 sc1
    s_waitcnt vmcnt(0)
L_chk5:
    v_xor_b32 v14, s12, v19
    v_bitop3_b32 v14, v14, v23, s12 bitop3:0xf6
    v_bitop3_b32 v14, v14, v27, s12 bitop3:0xf6
    v_bitop3_b32 v14, v14, v31, s12 bitop3:0xf6
    v_bitop3_b32 v14, v14, v35, s12 bitop3:0xf6
    v_bitop3_b32 v14, v14, v39, s12 bitop3:0xf6
    v_bitop3_b32 v14, v14, v43, s12 bitop3:0xf6
    v_bitop3_b32 v14, v14, v47, s12 bitop3:0xf6
    v_bitop3_b32 v14, v14, v51, s12 bitop3:0xf6
    v_bitop3_b32 v14, v14, v55, s12 bitop3:0xf6
    v_bitop3_b32 v14, v14, v59, s12 bitop3:0xf6
    v_bitop3_b32 v14, v14, v63, s12 bitop3:0xf6
    s_nop 1
    v_or_b32_dpp v14, v14, v14 quad_perm:[1,0,3,2] row_mask:0xf bank_mask:0xf
    s_nop 1
    v_or_b32_dpp v14, v14, v14 quad_perm:[2,3,0,1] row_mask:0xf bank_mask:0xf
    v_cmp_ne_u32 vcc, 0, v14
    s_nop 3
    s_cbranch_vccz L_done6
    s_mov_b64 exec, vcc
    s_add_u32 s13, s13, 1
    s_cmp_ge_u32 s13, 100000
    s_cbranch_scc1 L_done6
    s_sleep 1
    s_branch L_poll4
L_done6:
    s_mov_b64 exec, -1
    v_mov_b32 v19, v32
    v_mov_b32 v23, v33
    v_mov_b32 v27, v34
    v_mov_b32 v31, v36
    v_mov_b32 v43, v56
    v_mov_b32 v47, v57
    v_mov_b32 v51, v58
    v_mov_b32 v55, v60
    v_mov_b32 v10, 0x00003f80
    v_mov_b32 v11, 0x3f800000
    v_dot2_f32_bf16 v72, v16, v10, 0
    v_dot2_f32_bf16 v73, v16, v11, 0
    v_dot2_f32_bf16 v74, v17, v10, 0
    v_dot2_f32_bf16 v75, v17, v11, 0
    v_dot2_f32_bf16 v76, v18, v10, 0
    v_dot2_f32_bf16 v77, v18, v11, 0
    v_dot2_f32_bf16 v78, v19, v10, 0
    v_dot2_f32_bf16 v79, v19, v11, 0
    v_dot2_f32_bf16 v80, v20, v10, 0
    v_dot2_f32_bf16 v81, v20, v11, 0
    v_dot2_f32_bf16 v82, v21, v10, 0
    v_dot2_f32_bf16 v83, v21, v11, 0
    v_dot2_f32_bf16 v84, v22, v10, 0
    v_dot2_f32_bf16 v85, v22, v11, 0
    v_dot2_f32_bf16 v86, v23, v10, 0
    v_dot2_f32_bf16 v87, v23, v11, 0
    v_dot2_f32_bf16 v88, v24, v10, 0
    v_dot2_f32_bf16 v89, v24, v11, 0
    v_dot2_f32_bf16 v90, v25, v10, 0
    v_dot2_f32_bf16 v91, v25, v11, 0
    v_dot2_f32_bf16 v92, v26, v10, 0
    v_dot2_f32_bf16 v93, v26, v11, 0
    v_dot2_f32_bf16 v94, v27, v10, 0
    v_dot2_f32_bf16 v95, v27, v11, 0
    v_dot2_f32_bf16 v96, v28, v10, 0
    v_dot2_f32_bf16 v97, v28, v11, 0
    v_dot2_f32_bf16 v98, v29, v10, 0
    v_dot2_f32_bf16 v99, v29, v11, 0
    v_dot2_f32_bf16 v100, v30, v10, 0
    v_dot2_f32_bf16 v101, v30, v11, 0
    v_dot2_f32_bf16 v102, v31, v10, 0
    v_dot2_f32_bf16 v103, v31, v11, 0
    v_dot2_f32_bf16 v72, v40, v10, v72
    v_dot2_f32_bf16 v73, v40, v11, v73
    v_dot2_f32_bf16 v74, v41, v10, v74
    v_dot2_f32_bf16 v75, v41, v11, v75
    v_dot2_f32_bf16 v76, v42, v10, v76
    v_dot2_f32_bf16 v77, v42, v11, v77
    v_dot2_f32_bf16 v78, v43, v10, v78
    v_dot2_f32_bf16 v79, v43, v11, v79
    v_dot2_f32_bf16 v80, v44, v10, v80
    v_dot2_f32_bf16 v81, v44, v11, v81
    v_dot2_f32_bf16 v82, v45, v10, v82
    v_dot2_f32_bf16 v83, v45, v11, v83
    v_dot2_f32_bf16 v84, v46, v10, v84
    v_dot2_f32_bf16 v85, v46, v11, v85
    v_dot2_f32_bf16 v86, v47, v10, v86
    v_dot2_f32_bf16 v87, v47, v11, v87
    v_dot2_f32_bf16 v88, v48, v10, v88
    v_dot2_f32_bf16 v89, v48, v11, v89
    v_dot2_f32_bf16 v90, v49, v10, v90
    v_dot2_f32_bf16 v91, v49, v11, v91
    v_dot2_f32_bf16 v92, v50, v10, v92
    v_dot2_f32_bf16 v93, v50, v11, v93
    v_dot2_f32_bf16 v94, v51, v10, v94
    v_dot2_f32_bf16 v95, v51, v11, v95
    v_dot2_f32_bf16 v96, v52, v10, v96
    v_dot2_f32_bf16 v97, v52, v11, v97
    v_dot2_f32_bf16 v98, v53, v10, v98
    v_dot2_f32_bf16 v99, v53, v11, v99
    v_dot2_f32_bf16 v100, v54, v10, v100
    v_dot2_f32_bf16 v101, v54, v11, v101
    v_dot2_f32_bf16 v102, v55, v10, v102
    v_dot2_f32_bf16 v103, v55, v11, v103
    v_add_f32_dpp v104, v72, v72 row_shl:8 row_mask:0xf bank_mask:0x3
    s_nop 1
    v_add_f32_dpp v104, v88, v88 row_shr:8 row_mask:0xf bank_mask:0xc
    v_add_f32_dpp v105, v73, v73 row_shl:8 row_mask:0xf bank_mask:0x3
    s_nop 1
    v_add_f32_dpp v105, v89, v89 row_shr:8 row_mask:0xf bank_mask:0xc
    v_add_f32_dpp v106, v74, v74 row_shl:8 row_mask:0xf bank_mask:0x3
    s_nop 1
    v_add_f32_dpp v106, v90, v90 row_shr:8 row_mask:0xf bank_mask:0xc
    v_add_f32_dpp v107, v75, v75 row_shl:8 row_mask:0xf bank_mask:0x3
    s_nop 1
    v_add_f32_dpp v107, v91, v91 row_shr:8 row_mask:0xf bank_mask:0xc
    v_add_f32_dpp v108, v76, v76 row_shl:8 row_mask:0xf bank_mask:0x3
    s_nop 1
    v_add_f32_dpp v108, v92, v92 row_shr:8 row_mask:0xf bank_mask:0xc
    v_add_f32_dpp v109, v77, v77 row_shl:8 row_mask:0xf bank_mask:0x3
    s_nop 1
    v_add_f32_dpp v109, v93, v93 row_shr:8 row_mask:0xf bank_mask:0xc
    v_add_f32_dpp v110, v78, v78 row_shl:8 row_mask:0xf bank_mask:0x3
    s_nop 1
    v_add_f32_dpp v110, v94, v94 row_shr:8 row_mask:0xf bank_mask:0xc
    v_add_f32_dpp v111, v79, v79 row_shl:8 row_mask:0xf bank_mask:0x3
    s_nop 1
    v_add_f32_dpp v111, v95, v95 row_shr:8 row_mask:0xf bank_mask:0xc
    v_add_f32_dpp v112, v80, v80 row_shl:8 row_mask:0xf bank_mask:0x3
    s_nop 1
    v_add_f32_dpp v112, v96, v96 row_shr:8 row_mask:0xf bank_mask:0xc
    v_add_f32_dpp v113, v81, v81 row_shl:8 row_mask:0xf bank_mask:0x3
    s_nop 1
    v_add_f32_dpp v113, v97, v97 row_shr:8 row_mask:0xf bank_mask:0xc
    v_add_f32_dpp v114, v82, v82 row_shl:8 row_mask:0xf bank_mask:0x3
    s_nop 1
    v_add_f32_dpp v114, v98, v98 row_shr:8 row_mask:0xf bank_mask:0xc
    v_add_f32_dpp v115, v83, v83 row_shl:8 row_mask:0xf bank_mask:0x3
    s_nop 1
    v_add_f32_dpp v115, v99, v99 row_shr:8 row_mask:0xf bank_mask:0xc
    v_add_f32_dpp v116, v84, v84 row_shl:8 row_mask:0xf bank_mask:0x3
    s_nop 1
    v_add_f32_dpp v116, v100, v100 row_shr:8 row_mask:0xf bank_mask:0xc
    v_add_f32_dpp v117, v85, v85 row_shl:8 row_mask:0xf bank_mask:0x3
    s_nop 1
    v_add_f32_dpp v117, v101, v101 row_shr:8 row_mask:0xf bank_mask:0xc
    v_add_f32_dpp v118, v86, v86 row_shl:8 row_mask:0xf bank_mask:0x3
    s_nop 1
    v_add_f32_dpp v118, v102, v102 row_shr:8 row_mask:0xf bank_mask:0xc
    v_add_f32_dpp v119, v87, v87 row_shl:8 row_mask:0xf bank_mask:0x3
    s_nop 1
    v_add_f32_dpp v119, v103, v103 row_shr:8 row_mask:0xf bank_mask:0xc
    v_add_f32_dpp v16, v104, v104 row_shl:4 row_mask:0xf bank_mask:0x5
    s_nop 1
    v_add_f32_dpp v16, v112, v112 row_shr:4 row_mask:0xf bank_mask:0xa
    v_add_f32_dpp v17, v105, v105 row_shl:4 row_mask:0xf bank_mask:0x5
    s_nop 1
    v_add_f32_dpp v17, v113, v113 row_shr:4 row_mask:0xf bank_mask:0xa
    v_add_f32_dpp v18, v106, v106 row_shl:4 row_mask:0xf bank_mask:0x5
    s_nop 1
    v_add_f32_dpp v18, v114, v114 row_shr:4 row_mask:0xf bank_mask:0xa
    v_add_f32_dpp v19, v107, v107 row_shl:4 row_mask:0xf bank_mask:0x5
    s_nop 1
    v_add_f32_dpp v19, v115, v115 row_shr:4 row_mask:0xf bank_mask:0xa
    v_add_f32_dpp v20, v108, v108 row_shl:4 row_mask:0xf bank_mask:0x5
    s_nop 1
    v_add_f32_dpp v20, v116, v116 row_shr:4 row_mask:0xf bank_mask:0xa
    v_add_f32_dpp v21, v109, v109 row_shl:4 row_mask:0xf bank_mask:0x5
    s_nop 1
    v_add_f32_dpp v21, v117, v117 row_shr:4 row_mask:0xf bank_mask:0xa
    v_add_f32_dpp v22, v110, v110 row_shl:4 row_mask:0xf bank_mask:0x5
    s_nop 1
    v_add_f32_dpp v22, v118, v118 row_shr:4 row_mask:0xf bank_mask:0xa
    v_add_f32_dpp v23, v111, v111 row_shl:4 row_mask:0xf bank_mask:0x5
    s_nop 1
    v_add_f32_dpp v23, v119, v119 row_shr:4 row_mask:0xf bank_mask:0xa
    v_lshlrev_b32 v24, 16, v64
    v_and_b32 v25, 0xffff0000, v64
    v_lshlrev_b32 v26, 16, v65
    v_and_b32 v27, 0xffff0000, v65
    v_lshlrev_b32 v28, 16, v66
    v_and_b32 v29, 0xffff0000, v66
    v_lshlrev_b32 v30, 16, v67
    v_and_b32 v31, 0xffff0000, v67
    s_mov_b32 s4, 0xbdd2d3e8
    v_mov_b32 v12, 0xc0135761
    v_add_f32 v16, v16, v24
    v_add_f32 v17, v17, v25
    v_add_f32 v18, v18, v26
    v_add_f32 v19, v19, v27
    v_add_f32 v20, v20, v28
    v_add_f32 v21, v21, v29
    v_add_f32 v22, v22, v30
    v_add_f32 v23, v23, v31
    v_mul_f32 v24, v16, v16
    v_mul_f32 v25, v17, v17
    v_mul_f32 v26, v18, v18
    v_mul_f32 v27, v19, v19
    v_mul_f32 v28, v20, v20
    v_mul_f32 v29, v21, v21
    v_mul_f32 v30, v22, v22
    v_mul_f32 v31, v23, v23
    v_fma_f32 v24, v24, s4, v12
    v_fma_f32 v25, v25, s4, v12
    v_fma_f32 v26, v26, s4, v12
    v_fma_f32 v27, v27, s4, v12
    v_fma_f32 v28, v28, s4, v12
    v_fma_f32 v29, v29, s4, v12
    v_fma_f32 v30, v30, s4, v12
    v_fma_f32 v31, v31, s4, v12
    v_mul_f32 v24, v24, v16
    v_mul_f32 v25, v25, v17
    v_mul_f32 v26, v26, v18
    v_mul_f32 v27, v27, v19
    v_mul_f32 v28, v28, v20
    v_mul_f32 v29, v29, v21
    v_mul_f32 v30, v30, v22
    v_mul_f32 v31, v31, v23
    v_exp_f32 v24, v24
    v_exp_f32 v25, v25
    v_exp_f32 v26, v26
    v_exp_f32 v27, v27
    v_exp_f32 v28, v28
    v_exp_f32 v29, v29
    v_exp_f32 v30, v30
    v_exp_f32 v31, v31
    v_add_f32 v24, 1.0, v24
    v_add_f32 v25, 1.0, v25
    v_add_f32 v26, 1.0, v26
    v_add_f32 v27, 1.0, v27
    v_add_f32 v28, 1.0, v28
    v_add_f32 v29, 1.0, v29
    v_add_f32 v30, 1.0, v30
    v_add_f32 v31, 1.0, v31
    v_rcp_f32 v24, v24
    v_rcp_f32 v25, v25
    v_rcp_f32 v26, v26
    v_rcp_f32 v27, v27
    v_rcp_f32 v28, v28
    v_rcp_f32 v29, v29
    v_rcp_f32 v30, v30
    v_rcp_f32 v31, v31
    v_mul_f32 v16, v16, v24
    v_mul_f32 v17, v17, v25
    v_mul_f32 v18, v18, v26
    v_mul_f32 v19, v19, v27
    v_mul_f32 v20, v20, v28
    v_mul_f32 v21, v21, v29
    v_mul_f32 v22, v22, v30
    v_mul_f32 v23, v23, v31
    v_cvt_pk_bf16_f32 v32, v16, v17
    v_cvt_pk_bf16_f32 v33, v18, v19
    v_cvt_pk_bf16_f32 v34, v20, v21
    v_cvt_pk_bf16_f32 v35, v22, v23
    s_waitcnt vmcnt(0)
    ds_read_b64_tr_b16 v[128:129], v68 offset:0
    ds_read_b64_tr_b16 v[130:131], v70 offset:512
    ds_read_b64_tr_b16 v[132:133], v69 offset:0
    ds_read_b64_tr_b16 v[134:135], v71 offset:512
    ds_read_b64_tr_b16 v[136:137], v70 offset:0
    ds_read_b64_tr_b16 v[138:139], v68 offset:512
    ds_read_b64_tr_b16 v[140:141], v71 offset:0
    ds_read_b64_tr_b16 v[142:143], v69 offset:512
    ds_read_b64_tr_b16 v[144:145], v68 offset:1024
    ds_read_b64_tr_b16 v[146:147], v70 offset:1536
    ds_read_b64_tr_b16 v[148:149], v69 offset:1024
    ds_read_b64_tr_b16 v[150:151], v71 offset:1536
    ds_read_b64_tr_b16 v[152:153], v70 offset:1024
    ds_read_b64_tr_b16 v[154:155], v68 offset:1536
    ds_read_b64_tr_b16 v[156:157], v71 offset:1024
    ds_read_b64_tr_b16 v[158:159], v69 offset:1536
    ds_read_b64_tr_b16 v[160:161], v68 offset:2048
    ds_read_b64_tr_b16 v[162:163], v70 offset:2560
    ds_read_b64_tr_b16 v[164:165], v69 offset:2048
    ds_read_b64_tr_b16 v[166:167], v71 offset:2560
    ds_read_b64_tr_b16 v[168:169], v70 offset:2048
    ds_read_b64_tr_b16 v[170:171], v68 offset:2560
    ds_read_b64_tr_b16 v[172:173], v71 offset:2048
    ds_read_b64_tr_b16 v[174:175], v69 offset:2560
    ds_read_b64_tr_b16 v[176:177], v68 offset:3072
    ds_read_b64_tr_b16 v[178:179], v70 offset:3584
    ds_read_b64_tr_b16 v[180:181], v69 offset:3072
    ds_read_b64_tr_b16 v[182:183], v71 offset:3584
    ds_read_b64_tr_b16 v[184:185], v70 offset:3072
    ds_read_b64_tr_b16 v[186:187], v68 offset:3584
    ds_read_b64_tr_b16 v[188:189], v71 offset:3072
    ds_read_b64_tr_b16 v[190:191], v69 offset:3584
    v_lshrrev_b32 v3, 2, v1
    v_cmp_eq_u32 vcc, 0, v3
    s_nop 1
    v_cndmask_b32 v36, 0, v32, vcc
    v_cndmask_b32 v37, 0, v33, vcc
    v_cndmask_b32 v38, 0, v34, vcc
    v_cndmask_b32 v39, 0, v35, vcc
    v_cmp_eq_u32 vcc, 1, v3
    s_nop 1
    v_cndmask_b32 v40, 0, v32, vcc
    v_cndmask_b32 v41, 0, v33, vcc
    v_cndmask_b32 v42, 0, v34, vcc
    v_cndmask_b32 v43, 0, v35, vcc
    v_cmp_eq_u32 vcc, 2, v3
    s_nop 1
    v_cndmask_b32 v44, 0, v32, vcc
    v_cndmask_b32 v45, 0, v33, vcc
    v_cndmask_b32 v46, 0, v34, vcc
    v_cndmask_b32 v47, 0, v35, vcc
    v_cmp_eq_u32 vcc, 3, v3
    s_nop 1
    v_cndmask_b32 v48, 0, v32, vcc
    v_cndmask_b32 v49, 0, v33, vcc
    v_cndmask_b32 v50, 0, v34, vcc
    v_cndmask_b32 v51, 0, v35, vcc
    s_waitcnt lgkmcnt(15)
    v_mfma_f32_16x16x32_bf16 v[96:99], v[36:39], v[128:131], 0
    v_mfma_f32_16x16x32_bf16 v[100:103], v[36:39], v[132:135], 0
    v_mfma_f32_16x16x32_bf16 v[104:107], v[36:39], v[136:139], 0
    v_mfma_f32_16x16x32_bf16 v[108:111], v[36:39], v[140:143], 0
    s_waitcnt lgkmcnt(15)
    v_mfma_f32_16x16x32_bf16 v[96:99], v[40:43], v[144:147], v[96:99]
    v_mfma_f32_16x16x32_bf16 v[100:103], v[40:43], v[148:151], v[100:103]
    v_mfma_f32_16x16x32_bf16 v[104:107], v[40:43], v[152:155], v[104:107]
    v_mfma_f32_16x16x32_bf16 v[108:111], v[40:43], v[156:159], v[108:111]
    s_waitcnt lgkmcnt(8)
    v_mfma_f32_16x16x32_bf16 v[96:99], v[44:47], v[160:163], v[96:99]
    v_mfma_f32_16x16x32_bf16 v[100:103], v[44:47], v[164:167], v[100:103]
    v_mfma_f32_16x16x32_bf16 v[104:107], v[44:47], v[168:171], v[104:107]
    v_mfma_f32_16x16x32_bf16 v[108:111], v[44:47], v[172:175], v[108:111]
    s_waitcnt lgkmcnt(0)
    v_mfma_f32_16x16x32_bf16 v[96:99], v[48:51], v[176:179], v[96:99]
    v_mfma_f32_16x16x32_bf16 v[100:103], v[48:51], v[180:183], v[100:103]
    v_mfma_f32_16x16x32_bf16 v[104:107], v[48:51], v[184:187], v[104:107]
    v_mfma_f32_16x16x32_bf16 v[108:111], v[48:51], v[188:191], v[108:111]
    v_mul_u32_u24 v14, 159744, v2
    v_lshl_add_u32 v14, v1, 4, v14
    s_add_u32 s6, s68, 64
    s_lshl_b32 s6, s6, 11
    s_lshl_b32 s4, s69, 8
    s_add_u32 s6, s6, s4
    s_add_u32 s6, s6, 1310720
    v_mov_b32 v19, s12
    v_permlane32_swap_b32 v96, v98
    v_permlane32_swap_b32 v97, v99
    v_permlane32_swap_b32 v100, v102
    v_permlane32_swap_b32 v101, v103
    v_permlane32_swap_b32 v104, v106
    v_permlane32_swap_b32 v105, v107
    v_permlane32_swap_b32 v108, v110
    v_permlane32_swap_b32 v109, v111
    v_add_f32 v96, v96, v98
    v_add_f32 v97, v97, v99
    v_add_f32 v100, v100, v102
    v_add_f32 v101, v101, v103
    v_add_f32 v104, v104, v106
    v_add_f32 v105, v105, v107
    v_add_f32 v108, v108, v110
    v_add_f32 v109, v109, v111
    v_permlane16_swap_b32 v96, v97
    v_permlane16_swap_b32 v100, v101
    v_permlane16_swap_b32 v104, v105
    v_permlane16_swap_b32 v108, v109
    v_add_f32 v96, v96, v97
    v_add_f32 v100, v100, v101
    v_add_f32 v104, v104, v105
    v_add_f32 v108, v108, v109
    v_cvt_pk_bf16_f32 v16, v96, v100
    v_cvt_pk_bf16_f32 v17, v104, v108
    buffer_store_dwordx4 v[16:19], v14, s[44:47], s6 offen sc1
    s_endpgm
    s_nop 0
L_W:
    s_mov_b32 s44, s42
    s_and_b32 s45, s43, 0xffff
    s_mov_b32 s46, 0x10000000
    s_mov_b32 s47, 0x20000
    s_mov_b32 s56, s22
    s_and_b32 s57, s23, 0xffff
    s_mov_b32 s58, 4194304
    s_mov_b32 s59, 0x20000
    s_lshr_b32 s4, s61, 3
    s_lshl_b32 s4, s4, 3
    s_add_u32 s68, s60, s4
    s_and_b32 s69, s61, 7
    s_cmp_lt_u32 s68, 14
    s_cselect_b32 s70, 1, 99
    s_lshl_b32 s5, s65, 20
    s_lshl_b32 s4, s3, 17
    s_add_u32 s5, s5, s4
    s_add_u32 s15, s5, s6
    s_lshl_b32 s7, s3, 12
    s_add_u32 s7, s7, 24576
    v_lshlrev_b32 v6, 13, v2
    v_add_u32 v7, 4, v2
    v_and_b32 v7, 15, v7
    v_xor_b32 v7, v7, v1
    v_lshl_add_u32 v220, v7, 4, v6
    v_add_u32 v7, 8, v2
    v_and_b32 v7, 15, v7
    v_xor_b32 v7, v7, v1
    v_lshl_add_u32 v221, v7, 4, v6
    v_add_u32 v7, 12, v2
    v_and_b32 v7, 15, v7
    v_xor_b32 v7, v7, v1
    v_lshl_add_u32 v222, v7, 4, v6
    v_add_u32 v7, 16, v2
    v_and_b32 v7, 15, v7
    v_xor_b32 v7, v7, v1
    v_lshl_add_u32 v223, v7, 4, v6
    v_lshrrev_b32 v4, 2, v1
    v_lshlrev_b32 v4, 10, v4
    v_lshl_add_u32 v4, v2, 3, v4
    s_lshl_b32 s4, s3, 7
    s_add_u32 s4, s4, 8192
    v_add_u32 v4, s4, v4
    s_add_u32 s4, s65, 0
    s_and_b32 s4, s4, 3
    s_lshl_b32 s18, s4, 17
    s_add_u32 s18, s18, s14
    s_lshl_b32 s4, s4, 5
    v_add_u32 v232, s4, v4
    s_add_u32 s4, s65, 1
    s_and_b32 s4, s4, 3
    s_lshl_b32 s19, s4, 17
    s_add_u32 s19, s19, s14
    s_lshl_b32 s4, s4, 5
    v_add_u32 v233, s4, v4
    s_add_u32 s4, s65, 2
    s_and_b32 s4, s4, 3
    s_lshl_b32 s20, s4, 17
    s_add_u32 s20, s20, s14
    s_lshl_b32 s4, s4, 5
    v_add_u32 v234, s4, v4
    s_add_u32 s4, s65, 3
    s_and_b32 s4, s4, 3
    s_lshl_b32 s21, s4, 17
    s_add_u32 s21, s21, s14
    s_lshl_b32 s4, s4, 5
    v_add_u32 v235, s4, v4
    v_lshlrev_b32 v236, 8, v2
    v_lshl_add_u32 v236, v1, 2, v236
    s_lshr_b32 s4, s3, 2
    s_lshl_b32 s4, s4, 10
    s_and_b32 s5, s3, 3
    s_lshl_b32 s5, s5, 6
    s_add_u32 s4, s4, s5
    s_add_u32 s4, s4, 12288
    v_add_u32 v236, s4, v236
    v_lshlrev_b32 v237, 8, v1
    v_lshl_add_u32 v237, v2, 3, v237
    s_lshl_b32 s4, s3, 5
    s_add_u32 s4, s4, 20480
    v_add_u32 v237, s4, v237
    v_lshlrev_b32 v238, 15, v2
    v_lshl_add_u32 v238, v1, 4, v238
    s_lshl_b32 s22, s62, 10
    s_lshl_b32 s4, s65, 8
    s_add_u32 s22, s22, s4
    s_add_u32 s22, s22, 1048576
    v_lshlrev_b32 v6, 8, v1
    v_add_u32 v6, s7, v6
    v_add_u32 v7, 4, v1
    v_and_b32 v7, 15, v7
    v_lshlrev_b32 v8, 2, v2
    v_add_u32 v9, 0, v8
    v_xor_b32 v9, v9, v7
    v_lshl_add_u32 v240, v9, 4, v6
    v_add_u32 v9, 1, v8
    v_xor_b32 v9, v9, v7
    v_lshl_add_u32 v241, v9, 4, v6
    v_add_u32 v9, 2, v8
    v_xor_b32 v9, v9, v7
    v_lshl_add_u32 v242, v9, 4, v6
    v_add_u32 v9, 3, v8
    v_xor_b32 v9, v9, v7
    v_lshl_add_u32 v243, v9, 4, v6
    s_mov_b32 s28, 0x11111111
    s_mov_b32 s29, 0x11111111
    s_mov_b32 s32, 0x000f000f
    s_mov_b32 s33, 0x000f000f
    v_mov_b32 v12, 0x3f803f80
    v_mov_b32 v216, 0xfffe0000
    s_waitcnt lgkmcnt(0)
    s_add_u32 s12, s12, 2654435761
    v_and_b32 v4, 1, v2
    v_lshlrev_b32 v4, 1, v4
    v_add_u32 v4, s12, v4
    v_bfe_u32 v228, v4, 0, 1
    v_lshlrev_b32 v228, 16, v228
    v_sub_u32 v224, 0x10000, v228
    v_bfe_u32 v229, v4, 1, 1
    v_lshlrev_b32 v229, 16, v229
    v_sub_u32 v225, 0x10000, v229
    v_add_u32 v4, 1, v4
    v_bfe_u32 v230, v4, 0, 1
    v_lshlrev_b32 v230, 16, v230
    v_sub_u32 v226, 0x10000, v230
    v_bfe_u32 v231, v4, 1, 1
    v_lshlrev_b32 v231, 16, v231
    v_sub_u32 v227, 0x10000, v231
    s_waitcnt vmcnt(4)
    s_barrier
    ds_read_b128 v[16:19], v3 offset:8192
    ds_read_b128 v[20:23], v3 offset:9216
    ds_read_b128 v[24:27], v3 offset:10240
    ds_read_b128 v[28:31], v3 offset:11264
    ds_read_b64 v[32:33], v232
    ds_read_b64 v[34:35], v233
    ds_read_b64 v[36:37], v234
    ds_read_b64 v[38:39], v235
    s_waitcnt lgkmcnt(4)
    v_dot2_f32_bf16 v104, v16, v12, 0
    v_dot2_f32_bf16 v108, v16, v16, 0
    v_dot2_f32_bf16 v105, v20, v12, 0
    v_dot2_f32_bf16 v109, v20, v20, 0
    v_dot2_f32_bf16 v106, v24, v12, 0
    v_dot2_f32_bf16 v110, v24, v24, 0
    v_dot2_f32_bf16 v107, v28, v12, 0
    v_dot2_f32_bf16 v111, v28, v28, 0
    v_dot2_f32_bf16 v104, v17, v12, v104
    v_dot2_f32_bf16 v108, v17, v17, v108
    v_dot2_f32_bf16 v105, v21, v12, v105
    v_dot2_f32_bf16 v109, v21, v21, v109
    v_dot2_f32_bf16 v106, v25, v12, v106
    v_dot2_f32_bf16 v110, v25, v25, v110
    v_dot2_f32_bf16 v107, v29, v12, v107
    v_dot2_f32_bf16 v111, v29, v29, v111
    v_dot2_f32_bf16 v104, v18, v12, v104
    v_dot2_f32_bf16 v108, v18, v18, v108
    v_dot2_f32_bf16 v105, v22, v12, v105
    v_dot2_f32_bf16 v109, v22, v22, v109
    v_dot2_f32_bf16 v106, v26, v12, v106
    v_dot2_f32_bf16 v110, v26, v26, v110
    v_dot2_f32_bf16 v107, v30, v12, v107
    v_dot2_f32_bf16 v111, v30, v30, v111
    v_dot2_f32_bf16 v104, v19, v12, v104
    v_dot2_f32_bf16 v108, v19, v19, v108
    v_dot2_f32_bf16 v105, v23, v12, v105
    v_dot2_f32_bf16 v109, v23, v23, v109
    v_dot2_f32_bf16 v106, v27, v12, v106
    v_dot2_f32_bf16 v110, v27, v27, v110
    v_dot2_f32_bf16 v107, v31, v12, v107
    v_dot2_f32_bf16 v111, v31, v31, v111
    v_permlane32_swap_b32 v104, v108
    v_permlane32_swap_b32 v105, v109
    v_permlane32_swap_b32 v106, v110
    v_permlane32_swap_b32 v107, v111
    v_add_f32 v104, v104, v108
    v_add_f32 v105, v105, v109
    v_add_f32 v106, v106, v110
    v_add_f32 v107, v107, v111
    v_add_f32_dpp v108, v104, v104 row_shl:8 row_mask:0xf bank_mask:0x3
    v_add_f32_dpp v109, v105, v105 row_shl:8 row_mask:0xf bank_mask:0x3
    s_nop 0
    v_add_f32_dpp v108, v106, v106 row_shr:8 row_mask:0xf bank_mask:0xc
    v_add_f32_dpp v109, v107, v107 row_shr:8 row_mask:0xf bank_mask:0xc
    s_nop 0
    v_add_f32_dpp v8, v108, v108 row_shl:4 row_mask:0xf bank_mask:0x5
    s_nop 1
    v_add_f32_dpp v8, v109, v109 row_shr:4 row_mask:0xf bank_mask:0xa
    s_nop 1
    v_add_f32_dpp v8, v8, v8 quad_perm:[1,0,3,2] row_mask:0xf bank_mask:0xf
    s_nop 1
    v_add_f32_dpp v8, v8, v8 quad_perm:[2,3,0,1] row_mask:0xf bank_mask:0xf
    v_mov_b32 v9, v8
    s_nop 1
    v_permlane16_swap_b32 v8, v9
    v_add_f32 v8, v8, v9
    v_mul_f32 v8, 0x3b000000, v8
    v_mov_b32 v9, v8
    s_nop 1
    v_permlane32_swap_b32 v8, v9
    v_fma_f32 v9, -v8, v8, v9
    v_max_f32 v9, 0, v9
    v_cvt_pk_bf16_f32 v10, v8, v9
    v_lshlrev_b32 v8, 16, v10
    v_and_b32 v9, 0xffff0000, v10
    v_add_f32 v9, 0x3727c5ac, v9
    v_cvt_pk_bf16_f32 v9, v9, v9
    v_and_b32 v9, 0xffff0000, v9
    v_sqrt_f32 v9, v9
    s_nop 0
    v_cvt_pk_bf16_f32 v9, v9, v9
    v_and_b32 v9, 0xffff0000, v9
    v_rcp_f32 v9, v9
    s_waitcnt lgkmcnt(0)
    v_lshlrev_b32 v104, 16, v32
    v_and_b32 v105, 0xffff0000, v32
    v_lshlrev_b32 v106, 16, v33
    v_and_b32 v107, 0xffff0000, v33
    v_lshlrev_b32 v108, 16, v34
    v_and_b32 v109, 0xffff0000, v34
    v_lshlrev_b32 v110, 16, v35
    v_and_b32 v111, 0xffff0000, v35
    v_lshlrev_b32 v112, 16, v36
    v_and_b32 v113, 0xffff0000, v36
    v_lshlrev_b32 v114, 16, v37
    v_and_b32 v115, 0xffff0000, v37
    v_lshlrev_b32 v116, 16, v38
    v_and_b32 v117, 0xffff0000, v38
    v_lshlrev_b32 v118, 16, v39
    v_and_b32 v119, 0xffff0000, v39
    v_sub_f32 v104, v104, v8
    v_sub_f32 v105, v105, v8
    v_sub_f32 v106, v106, v8
    v_sub_f32 v107, v107, v8
    v_sub_f32 v108, v108, v8
    v_sub_f32 v109, v109, v8
    v_sub_f32 v110, v110, v8
    v_sub_f32 v111, v111, v8
    v_sub_f32 v112, v112, v8
    v_sub_f32 v113, v113, v8
    v_sub_f32 v114, v114, v8
    v_sub_f32 v115, v115, v8
    v_sub_f32 v116, v116, v8
    v_sub_f32 v117, v117, v8
    v_sub_f32 v118, v118, v8
    v_sub_f32 v119, v119, v8
    v_cvt_pk_bf16_f32 v32, v104, v105
    v_cvt_pk_bf16_f32 v33, v106, v107
    v_cvt_pk_bf16_f32 v34, v108, v109
    v_cvt_pk_bf16_f32 v35, v110, v111
    v_cvt_pk_bf16_f32 v36, v112, v113
    v_cvt_pk_bf16_f32 v37, v114, v115
    v_cvt_pk_bf16_f32 v38, v116, v117
    v_cvt_pk_bf16_f32 v39, v118, v119
    v_lshlrev_b32 v104, 16, v32
    v_and_b32 v105, 0xffff0000, v32
    v_lshlrev_b32 v106, 16, v33
    v_and_b32 v107, 0xffff0000, v33
    v_lshlrev_b32 v108, 16, v34
    v_and_b32 v109, 0xffff0000, v34
    v_lshlrev_b32 v110, 16, v35
    v_and_b32 v111, 0xffff0000, v35
    v_lshlrev_b32 v112, 16, v36
    v_and_b32 v113, 0xffff0000, v36
    v_lshlrev_b32 v114, 16, v37
    v_and_b32 v115, 0xffff0000, v37
    v_lshlrev_b32 v116, 16, v38
    v_and_b32 v117, 0xffff0000, v38
    v_lshlrev_b32 v118, 16, v39
    v_and_b32 v119, 0xffff0000, v39
    v_mul_f32 v104, v104, v9
    v_mul_f32 v105, v105, v9
    v_mul_f32 v106, v106, v9
    v_mul_f32 v107, v107, v9
    v_mul_f32 v108, v108, v9
    v_mul_f32 v109, v109, v9
    v_mul_f32 v110, v110, v9
    v_mul_f32 v111, v111, v9
    v_mul_f32 v112, v112, v9
    v_mul_f32 v113, v113, v9
    v_mul_f32 v114, v114, v9
    v_mul_f32 v115, v115, v9
    v_mul_f32 v116, v116, v9
    v_mul_f32 v117, v117, v9
    v_mul_f32 v118, v118, v9
    v_mul_f32 v119, v119, v9
    v_cvt_pk_bf16_f32 v32, v104, v105
    v_cvt_pk_bf16_f32 v33, v106, v107
    v_cvt_pk_bf16_f32 v34, v108, v109
    v_cvt_pk_bf16_f32 v35, v110, v111
    v_cvt_pk_bf16_f32 v36, v112, v113
    v_cvt_pk_bf16_f32 v37, v114, v115
    v_cvt_pk_bf16_f32 v38, v116, v117
    v_cvt_pk_bf16_f32 v39, v118, v119
    v_mov_b32 v252, v8
    v_mov_b32 v253, v9
    buffer_load_dwordx4 v[56:59], v5, s[48:51], s19 offen
    s_add_u32 s19, s19, 8192
    buffer_load_dwordx4 v[60:63], v5, s[48:51], s19 offen
    s_add_u32 s19, s19, 8192
    buffer_load_dwordx4 v[64:67], v5, s[48:51], s19 offen
    s_add_u32 s19, s19, 8192
    buffer_load_dwordx4 v[68:71], v5, s[48:51], s19 offen
    buffer_load_dwordx4 v[72:75], v5, s[48:51], s20 offen
    s_add_u32 s20, s20, 8192
    buffer_load_dwordx4 v[76:79], v5, s[48:51], s20 offen
    s_add_u32 s20, s20, 8192
    buffer_load_dwordx4 v[80:83], v5, s[48:51], s20 offen
    s_add_u32 s20, s20, 8192
    buffer_load_dwordx4 v[84:87], v5, s[48:51], s20 offen
    buffer_load_dwordx4 v[88:91], v5, s[48:51], s21 offen
    s_add_u32 s21, s21, 8192
    buffer_load_dwordx4 v[92:95], v5, s[48:51], s21 offen
    s_add_u32 s21, s21, 8192
    buffer_load_dwordx4 v[96:99], v5, s[48:51], s21 offen
    s_add_u32 s21, s21, 8192
    buffer_load_dwordx4 v[100:103], v5, s[48:51], s21 offen
    s_mov_b32 m0, s7
    s_nop 0
    buffer_load_dwordx4 v220, s[56:59], s15 offen lds
    s_add_u32 s15, s15, 32768
    s_add_u32 m0, m0, 1024
    s_nop 0
    buffer_load_dwordx4 v221, s[56:59], s15 offen lds
    s_add_u32 s15, s15, 32768
    s_add_u32 m0, m0, 1024
    s_nop 0
    buffer_load_dwordx4 v222, s[56:59], s15 offen lds
    s_add_u32 s15, s15, 32768
    s_add_u32 m0, m0, 1024
    s_nop 0
    buffer_load_dwordx4 v223, s[56:59], s15 offen lds
    s_waitcnt vmcnt(16)
    v_perm_b32 v120, v44, v40, s10
    v_perm_b32 v121, v52, v48, s10
    v_perm_b32 v124, v44, v40, s11
    v_perm_b32 v125, v52, v48, s11
    v_perm_b32 v128, v45, v41, s10
    v_perm_b32 v129, v53, v49, s10
    v_perm_b32 v132, v45, v41, s11
    v_perm_b32 v133, v53, v49, s11
    v_perm_b32 v136, v46, v42, s10
    v_perm_b32 v137, v54, v50, s10
    v_perm_b32 v140, v46, v42, s11
    v_perm_b32 v141, v54, v50, s11
    v_perm_b32 v144, v47, v43, s10
    v_perm_b32 v145, v55, v51, s10
    v_perm_b32 v148, v47, v43, s11
    v_perm_b32 v149, v55, v51, s11
    s_waitcnt vmcnt(12)
    v_perm_b32 v122, v60, v56, s10
    v_perm_b32 v123, v68, v64, s10
    v_perm_b32 v126, v60, v56, s11
    v_perm_b32 v127, v68, v64, s11
    v_perm_b32 v130, v61, v57, s10
    v_perm_b32 v131, v69, v65, s10
    v_perm_b32 v134, v61, v57, s11
    v_perm_b32 v135, v69, v65, s11
    v_perm_b32 v138, v62, v58, s10
    v_perm_b32 v139, v70, v66, s10
    v_perm_b32 v142, v62, v58, s11
    v_perm_b32 v143, v70, v66, s11
    v_perm_b32 v146, v63, v59, s10
    v_perm_b32 v147, v71, v67, s10
    v_perm_b32 v150, v63, v59, s11
    v_perm_b32 v151, v71, v67, s11
    v_mfma_f32_16x16x32_bf16 v[184:187], v[120:123], v[32:35], 0
    v_mfma_f32_16x16x32_bf16 v[188:191], v[124:127], v[32:35], 0
    v_mfma_f32_16x16x32_bf16 v[192:195], v[128:131], v[32:35], 0
    v_mfma_f32_16x16x32_bf16 v[196:199], v[132:135], v[32:35], 0
    v_mfma_f32_16x16x32_bf16 v[200:203], v[136:139], v[32:35], 0
    v_mfma_f32_16x16x32_bf16 v[204:207], v[140:143], v[32:35], 0
    v_mfma_f32_16x16x32_bf16 v[208:211], v[144:147], v[32:35], 0
    v_mfma_f32_16x16x32_bf16 v[212:215], v[148:151], v[32:35], 0
    s_waitcnt vmcnt(8)
    v_perm_b32 v152, v76, v72, s10
    v_perm_b32 v153, v84, v80, s10
    v_perm_b32 v156, v76, v72, s11
    v_perm_b32 v157, v84, v80, s11
    v_perm_b32 v160, v77, v73, s10
    v_perm_b32 v161, v85, v81, s10
    v_perm_b32 v164, v77, v73, s11
    v_perm_b32 v165, v85, v81, s11
    v_perm_b32 v168, v78, v74, s10
    v_perm_b32 v169, v86, v82, s10
    v_perm_b32 v172, v78, v74, s11
    v_perm_b32 v173, v86, v82, s11
    v_perm_b32 v176, v79, v75, s10
    v_perm_b32 v177, v87, v83, s10
    v_perm_b32 v180, v79, v75, s11
    v_perm_b32 v181, v87, v83, s11
    s_waitcnt vmcnt(4)
    v_perm_b32 v154, v92, v88, s10
    v_perm_b32 v155, v100, v96, s10
    v_perm_b32 v158, v92, v88, s11
    v_perm_b32 v159, v100, v96, s11
    v_perm_b32 v162, v93, v89, s10
    v_perm_b32 v163, v101, v97, s10
    v_perm_b32 v166, v93, v89, s11
    v_perm_b32 v167, v101, v97, s11
    v_perm_b32 v170, v94, v90, s10
    v_perm_b32 v171, v102, v98, s10
    v_perm_b32 v174, v94, v90, s11
    v_perm_b32 v175, v102, v98, s11
    v_perm_b32 v178, v95, v91, s10
    v_perm_b32 v179, v103, v99, s10
    v_perm_b32 v182, v95, v91, s11
    v_perm_b32 v183, v103, v99, s11
    s_waitcnt vmcnt(0)
    ds_read_b128 v[104:107], v240
    ds_read_b128 v[108:111], v241
    ds_read_b128 v[112:115], v242
    ds_read_b128 v[116:119], v243
    v_mfma_f32_16x16x32_bf16 v[184:187], v[152:155], v[36:39], v[184:187]
    v_mfma_f32_16x16x32_bf16 v[188:191], v[156:159], v[36:39], v[188:191]
    v_mfma_f32_16x16x32_bf16 v[192:195], v[160:163], v[36:39], v[192:195]
    v_mfma_f32_16x16x32_bf16 v[196:199], v[164:167], v[36:39], v[196:199]
    v_mfma_f32_16x16x32_bf16 v[200:203], v[168:171], v[36:39], v[200:203]
    v_mfma_f32_16x16x32_bf16 v[204:207], v[172:175], v[36:39], v[204:207]
    v_mfma_f32_16x16x32_bf16 v[208:211], v[176:179], v[36:39], v[208:211]
    v_mfma_f32_16x16x32_bf16 v[212:215], v[180:183], v[36:39], v[212:215]
    s_nop 1
    v_cvt_pk_bf16_f32 v72, v184, v188
    v_cvt_pk_bf16_f32 v76, v185, v189
    v_cvt_pk_bf16_f32 v80, v186, v190
    v_cvt_pk_bf16_f32 v84, v187, v191
    v_cvt_pk_bf16_f32 v73, v192, v196
    v_cvt_pk_bf16_f32 v77, v193, v197
    v_cvt_pk_bf16_f32 v81, v194, v198
    v_cvt_pk_bf16_f32 v85, v195, v199
    v_cvt_pk_bf16_f32 v74, v200, v204
    v_cvt_pk_bf16_f32 v78, v201, v205
    v_cvt_pk_bf16_f32 v82, v202, v206
    v_cvt_pk_bf16_f32 v86, v203, v207
    v_cvt_pk_bf16_f32 v75, v208, v212
    v_cvt_pk_bf16_f32 v79, v209, v213
    v_cvt_pk_bf16_f32 v83, v210, v214
    v_cvt_pk_bf16_f32 v87, v211, v215
    s_mov_b64 exec, s[28:29]
    ds_write_b128 v236, v[72:75] offset:0
    ds_write_b128 v236, v[76:79] offset:2048
    ds_write_b128 v236, v[80:83] offset:4096
    ds_write_b128 v236, v[84:87] offset:6144
    s_mov_b64 exec, -1
    s_waitcnt lgkmcnt(0)
    s_barrier
    ds_read_b128 v[120:123], v3 offset:12288
    ds_read_b128 v[124:127], v3 offset:13312
    ds_read_b128 v[128:131], v3 offset:14336
    ds_read_b128 v[132:135], v3 offset:15360
    ds_read_b128 v[136:139], v3 offset:16384
    ds_read_b128 v[140:143], v3 offset:17408
    ds_read_b128 v[144:147], v3 offset:18432
    ds_read_b128 v[148:151], v3 offset:19456
    s_waitcnt lgkmcnt(6)
    v_mfma_f32_16x16x32_bf16 v[40:43], v[104:107], v[120:123], 0
    v_mfma_f32_16x16x32_bf16 v[44:47], v[104:107], v[124:127], 0
    s_waitcnt lgkmcnt(4)
    v_mfma_f32_16x16x32_bf16 v[40:43], v[108:111], v[128:131], v[40:43]
    v_mfma_f32_16x16x32_bf16 v[44:47], v[108:111], v[132:135], v[44:47]
    s_waitcnt lgkmcnt(2)
    v_mfma_f32_16x16x32_bf16 v[40:43], v[112:115], v[136:139], v[40:43]
    v_mfma_f32_16x16x32_bf16 v[44:47], v[112:115], v[140:143], v[44:47]
    s_waitcnt lgkmcnt(0)
    v_mfma_f32_16x16x32_bf16 v[40:43], v[116:119], v[144:147], v[40:43]
    v_mfma_f32_16x16x32_bf16 v[44:47], v[116:119], v[148:151], v[44:47]
    s_nop 7
    v_add_f32 v40, v40, v44
    v_add_f32 v41, v41, v45
    v_add_f32 v42, v42, v46
    v_add_f32 v43, v43, v47
    v_add_f32_dpp v40, v40, v40 row_ror:4 row_mask:0xf bank_mask:0xf
    v_add_f32_dpp v41, v41, v41 row_ror:4 row_mask:0xf bank_mask:0xf
    v_add_f32_dpp v42, v42, v42 row_ror:4 row_mask:0xf bank_mask:0xf
    v_add_f32_dpp v43, v43, v43 row_ror:4 row_mask:0xf bank_mask:0xf
    v_add_f32_dpp v40, v40, v40 row_ror:8 row_mask:0xf bank_mask:0xf
    v_add_f32_dpp v41, v41, v41 row_ror:8 row_mask:0xf bank_mask:0xf
    v_add_f32_dpp v42, v42, v42 row_ror:8 row_mask:0xf bank_mask:0xf
    v_add_f32_dpp v43, v43, v43 row_ror:8 row_mask:0xf bank_mask:0xf
    v_add_u32 v40, v40, v224
    v_add_u32 v41, v41, v225
    v_add_u32 v42, v42, v226
    v_add_u32 v43, v43, v227
    v_and_or_b32 v40, v40, v216, v228
    v_and_or_b32 v41, v41, v216, v229
    v_and_or_b32 v42, v42, v216, v230
    v_and_or_b32 v43, v43, v216, v231
    v_perm_b32 v44, v41, v40, s11
    v_perm_b32 v45, v43, v42, s11
    s_mov_b64 exec, s[32:33]
    ds_write_b64 v237, v[44:45]
    s_mov_b64 exec, -1
    s_waitcnt lgkmcnt(0)
    s_barrier
    s_cmp_lg_u32 s3, 0
    s_cbranch_scc1 L_nopub
    ds_read_b128 v[244:247], v3 offset:20480
    s_waitcnt lgkmcnt(0)
    buffer_store_dwordx4 v[244:247], v238, s[44:47], s22 offen sc1
    s_nop 1
L_nopub:
    s_barrier
    s_mov_b32 s48, s24
    s_and_b32 s49, s25, 0xffff
    s_mov_b32 s50, 4194304
    s_mov_b32 s51, 0x20000
    s_mov_b32 s52, s26
    s_and_b32 s53, s27, 0xffff
    s_mov_b32 s54, 4194304
    s_mov_b32 s55, 0x20000
    s_mov_b32 s56, s30
    s_and_b32 s57, s31, 0xffff
    s_mov_b32 s58, 1835008
    s_mov_b32 s59, 0x20000
    s_and_b32 s66, s65, 1
    s_lshr_b32 s67, s65, 1
    v_lshrrev_b32 v5, 3, v0
    v_and_b32 v6, 7, v0
    v_lshlrev_b32 v7, 1, v2
    v_xor_b32 v6, v6, v7
    v_lshlrev_b32 v6, 4, v6
    v_lshl_add_u32 v7, v5, 10, v6
    v_and_b32 v6, 7, v0
    v_lshlrev_b32 v6, 4, v6
    v_lshl_add_u32 v232, v5, 13, v6
    s_lshl_b32 s14, s3, 19
    s_lshl_b32 s4, s62, 8
    s_add_u32 s14, s14, s4
    s_lshl_b32 s4, s66, 7
    s_add_u32 s14, s14, s4
    s_lshl_b32 s15, s62, 17
    s_lshl_b32 s4, s66, 16
    s_add_u32 s15, s15, s4
    s_lshl_b32 s4, s3, 7
    s_add_u32 s15, s15, s4
    s_lshl_b32 s63, s3, 14
    s_add_u32 s63, s63, 32768
    s_xor_b32 s4, s67, 0
    s_lshl_b32 s5, s4, 6
    v_xor_b32 v233, s5, v232
    v_xor_b32 v234, 32, v233
    s_lshl_b32 s5, s4, 12
    s_add_u32 s34, s5, s63
    s_mov_b32 m0, s34
    s_lshl_b32 s5, s4, 18
    s_add_u32 s5, s5, s14
    s_lshl_b32 s35, s4, 15
    s_add_u32 s35, s35, s15
    buffer_load_dwordx4 v233, s[48:51], s5 offen lds
    s_add_u32 s5, s5, 65536
    s_add_u32 m0, m0, 1024
    s_nop 0
    buffer_load_dwordx4 v233, s[48:51], s5 offen lds
    s_add_u32 s5, s5, 65536
    s_add_u32 m0, m0, 1024
    s_nop 0
    buffer_load_dwordx4 v234, s[48:51], s5 offen lds
    s_add_u32 s5, s5, 65536
    s_add_u32 m0, m0, 1024
    s_nop 0
    buffer_load_dwordx4 v234, s[48:51], s5 offen lds
    s_add_u32 m0, s34, 8192
    s_nop 0
    buffer_load_dwordx4 v7, s[52:55], s35 offen lds
    s_add_u32 s35, s35, 8192
    s_add_u32 m0, m0, 1024
    s_nop 0
    buffer_load_dwordx4 v7, s[52:55], s35 offen lds
    s_add_u32 s35, s35, 8192
    s_add_u32 m0, m0, 1024
    s_nop 0
    buffer_load_dwordx4 v7, s[52:55], s35 offen lds
    s_add_u32 s35, s35, 8192
    s_add_u32 m0, m0, 1024
    s_nop 0
    buffer_load_dwordx4 v7, s[52:55], s35 offen lds
    s_waitcnt vmcnt(0)
    s_xor_b32 s4, s67, 1
    s_lshl_b32 s5, s4, 6
    v_xor_b32 v233, s5, v232
    v_xor_b32 v234, 32, v233
    s_lshl_b32 s5, s4, 12
    s_add_u32 s34, s5, s63
    s_mov_b32 m0, s34
    s_lshl_b32 s5, s4, 18
    s_add_u32 s5, s5, s14
    s_lshl_b32 s35, s4, 15
    s_add_u32 s35, s35, s15
    buffer_load_dwordx4 v233, s[48:51], s5 offen lds
    s_add_u32 s5, s5, 65536
    s_add_u32 m0, m0, 1024
    s_nop 0
    buffer_load_dwordx4 v233, s[48:51], s5 offen lds
    s_add_u32 s5, s5, 65536
    s_add_u32 m0, m0, 1024
    s_nop 0
    buffer_load_dwordx4 v234, s[48:51], s5 offen lds
    s_add_u32 s5, s5, 65536
    s_add_u32 m0, m0, 1024
    s_nop 0
    buffer_load_dwordx4 v234, s[48:51], s5 offen lds
    s_add_u32 m0, s34, 8192
    s_nop 0
    buffer_load_dwordx4 v7, s[52:55], s35 offen lds
    s_add_u32 s35, s35, 8192
    s_add_u32 m0, m0, 1024
    s_nop 0
    buffer_load_dwordx4 v7, s[52:55], s35 offen lds
    s_add_u32 s35, s35, 8192
    s_add_u32 m0, m0, 1024
    s_nop 0
    buffer_load_dwordx4 v7, s[52:55], s35 offen lds
    s_add_u32 s35, s35, 8192
    s_add_u32 m0, m0, 1024
    s_nop 0
    buffer_load_dwordx4 v7, s[52:55], s35 offen lds
    s_cmp_eq_u32 s3, s70
    s_cbranch_scc0 L_now1
    v_mul_u32_u24 v4, 28672, v2
    v_lshl_add_u32 v4, v1, 4, v4
    s_mul_i32 s5, s69, 229376
    s_lshl_b32 s4, s68, 8
    s_add_u32 s5, s5, s4
    s_waitcnt vmcnt(0)
    buffer_load_dwordx4 v[168:171], v4, s[56:59], s5 offen
    s_add_u32 s5, s5, 3584
    buffer_load_dwordx4 v[172:175], v4, s[56:59], s5 offen
    s_add_u32 s5, s5, 3584
    buffer_load_dwordx4 v[176:179], v4, s[56:59], s5 offen
    s_add_u32 s5, s5, 3584
    buffer_load_dwordx4 v[180:183], v4, s[56:59], s5 offen
    s_add_u32 s5, s5, 3584
    buffer_load_dwordx4 v[184:187], v4, s[56:59], s5 offen
    s_add_u32 s5, s5, 3584
    buffer_load_dwordx4 v[188:191], v4, s[56:59], s5 offen
    s_add_u32 s5, s5, 3584
    buffer_load_dwordx4 v[192:195], v4, s[56:59], s5 offen
    s_add_u32 s5, s5, 3584
    buffer_load_dwordx4 v[196:199], v4, s[56:59], s5 offen
    s_add_u32 s5, s5, 89600
    buffer_load_dwordx4 v[200:203], v4, s[56:59], s5 offen
    s_add_u32 s5, s5, 3584
    buffer_load_dwordx4 v[204:207], v4, s[56:59], s5 offen
    s_add_u32 s5, s5, 3584
    buffer_load_dwordx4 v[208:211], v4, s[56:59], s5 offen
    s_add_u32 s5, s5, 3584
    buffer_load_dwordx4 v[212:215], v4, s[56:59], s5 offen
    s_add_u32 s5, s5, 3584
    buffer_load_dwordx4 v[216:219], v4, s[56:59], s5 offen
    s_add_u32 s5, s5, 3584
    buffer_load_dwordx4 v[220:223], v4, s[56:59], s5 offen
    s_add_u32 s5, s5, 3584
    buffer_load_dwordx4 v[224:227], v4, s[56:59], s5 offen
    s_add_u32 s5, s5, 3584
    buffer_load_dwordx4 v[228:231], v4, s[56:59], s5 offen
L_now1:
    s_lshl_b32 s5, s62, 2
    s_lshl_b32 s4, s67, 1
    s_add_u32 s5, s5, s4
    s_lshl_b32 s6, s5, 3
    s_add_u32 s6, s6, s3
    s_lshl_b32 s6, s6, 12
    s_add_u32 s6, s6, 2097152
    s_add_u32 s7, s6, 32768
    s_and_b32 s5, s3, 1
    s_add_u32 s5, s5, s4
    s_lshl_b32 s5, s5, 14
    s_lshl_b32 s4, s62, 4
    s_add_u32 s5, s5, s4
    s_add_u32 s5, s5, 655360
    v_lshlrev_b32 v15, 4, v0
    v_and_b32 v3, 3, v0
    v_lshlrev_b32 v13, 12, v3
    v_lshrrev_b32 v3, 3, v0
    v_lshl_add_u32 v13, v3, 9, v13
    s_and_b32 s4, s3, 1
    s_lshl_b32 s4, s4, 10
    v_add_u32 v164, s4, v15
    v_and_b32 v3, 7, v0
    v_lshlrev_b32 v4, 1, v2
    v_xor_b32 v3, v3, v4
    v_lshlrev_b32 v3, 4, v3
    v_and_b32 v12, 0x380, v15
    v_add_u32 v12, v12, v3
    v_lshlrev_b32 v8, 2, v0
    s_lshl_b32 s4, s3, 9
    s_add_u32 s4, s4, 0
    v_add_u32 v8, s4, v8
    v_and_b32 v9, 1, v1
    v_lshlrev_b32 v9, 8, v9
    v_and_b32 v3, 1, v2
    v_lshl_add_u32 v9, v3, 7, v9
    v_lshrrev_b32 v3, 1, v2
    v_lshl_add_u32 v9, v3, 2, v9
    v_add_u32 v9, s4, v9
    v_lshlrev_b32 v10, 8, v2
    v_lshl_add_u32 v10, v1, 4, v10
    s_lshl_b32 s4, s3, 5
    s_add_u32 s4, s4, 4096
    v_add_u32 v10, s4, v10
    v_mov_b32 v247, s12
    v_lshrrev_b32 v7, 1, v2
    v_mul_u32_u24 v7, 159744, v7
    v_lshl_add_u32 v7, v1, 4, v7
    s_mul_i32 s71, s67, 319488
    s_lshl_b32 s4, s62, 1
    s_add_u32 s4, s4, s66
    s_lshl_b32 s4, s4, 11
    s_add_u32 s71, s71, s4
    s_lshl_b32 s4, s3, 8
    s_add_u32 s71, s71, s4
    s_add_u32 s71, s71, 1310720
    s_add_u32 s4, s63, 4096
    s_cmp_eq_u32 s66, 0
    s_cselect_b32 s18, s6, s7
    s_cselect_b32 s19, s7, s6
    s_cselect_b32 s20, s63, s4
    s_cselect_b32 s21, s4, s63
    v_lshrrev_b32 v3, 2, v1
    v_lshl_add_u32 v3, v2, 2, v3
    v_bfe_u32 v4, v3, 1, 2
    v_lshlrev_b32 v4, 1, v4
    v_lshlrev_b32 v3, 7, v3
    v_and_b32 v5, 1, v1
    v_lshl_add_u32 v3, v5, 3, v3
    v_add_u32 v3, s63, v3
    v_bfe_u32 v5, v1, 1, 1
    v_add_u32 v6, 0, v5
    v_xor_b32 v6, v6, v4
    v_lshl_add_u32 v240, v6, 4, v3
    v_add_u32 v6, 2, v5
    v_xor_b32 v6, v6, v4
    v_lshl_add_u32 v241, v6, 4, v3
    v_add_u32 v6, 4, v5
    v_xor_b32 v6, v6, v4
    v_lshl_add_u32 v242, v6, 4, v3
    v_add_u32 v6, 6, v5
    v_xor_b32 v6, v6, v4
    v_lshl_add_u32 v243, v6, 4, v3
    v_lshrrev_b32 v4, 2, v1
    v_lshrrev_b32 v3, 1, v2
    v_lshl_add_u32 v3, v4, 4, v3
    v_and_b32 v6, 1, v2
    v_lshl_add_u32 v3, v6, 3, v3
    v_lshlrev_b32 v4, 1, v4
    v_lshlrev_b32 v3, 7, v3
    v_and_b32 v6, 1, v1
    v_lshl_add_u32 v3, v6, 3, v3
    v_add_u32 v3, s63, v3
    v_add_u32 v6, 0, v5
    v_xor_b32 v6, v6, v4
    v_lshl_add_u32 v236, v6, 4, v3
    v_add_u32 v6, 2, v5
    v_xor_b32 v6, v6, v4
    v_lshl_add_u32 v237, v6, 4, v3
    v_add_u32 v6, 4, v5
    v_xor_b32 v6, v6, v4
    v_lshl_add_u32 v238, v6, 4, v3
    v_add_u32 v6, 6, v5
    v_xor_b32 v6, v6, v4
    v_lshl_add_u32 v239, v6, 4, v3
    s_add_u32 s4, s12, 0
    v_mov_b32 v11, s4
    v_and_b32 v248, 1, v11
    v_bfe_u32 v4, v11, 1, 1
    v_lshl_or_b32 v248, v4, 16, v248
    s_add_u32 s4, s12, 1
    v_mov_b32 v11, s4
    v_and_b32 v249, 1, v11
    v_bfe_u32 v4, v11, 1, 1
    v_lshl_or_b32 v249, v4, 16, v249
    s_add_u32 s4, s12, 2
    v_mov_b32 v11, s4
    v_and_b32 v250, 1, v11
    v_bfe_u32 v4, v11, 1, 1
    v_lshl_or_b32 v250, v4, 16, v250
    s_add_u32 s4, s12, 3
    v_mov_b32 v11, s4
    v_and_b32 v251, 1, v11
    v_bfe_u32 v4, v11, 1, 1
    v_lshl_or_b32 v251, v4, 16, v251
    v_add_u32 v165, s63, v15
    v_mov_b32 v166, 0x00010001
    s_cmp_eq_u32 s3, s70
    s_cbranch_scc1 L_nowt
    s_waitcnt vmcnt(0)
L_nowt:
    ds_read_b64_tr_b16 v[16:17], v236 offset:0
    ds_read_b64_tr_b16 v[18:19], v236 offset:256
    ds_read_b64_tr_b16 v[20:21], v237 offset:0
    ds_read_b64_tr_b16 v[22:23], v237 offset:256
    ds_read_b64_tr_b16 v[24:25], v238 offset:0
    ds_read_b64_tr_b16 v[26:27], v238 offset:256
    ds_read_b64_tr_b16 v[28:29], v239 offset:0
    ds_read_b64_tr_b16 v[30:31], v239 offset:256
    ds_read_b64_tr_b16 v[32:33], v236 offset:512
    ds_read_b64_tr_b16 v[34:35], v236 offset:768
    ds_read_b64_tr_b16 v[36:37], v237 offset:512
    ds_read_b64_tr_b16 v[38:39], v237 offset:768
    ds_read_b64_tr_b16 v[40:41], v238 offset:512
    ds_read_b64_tr_b16 v[42:43], v238 offset:768
    ds_read_b64_tr_b16 v[44:45], v239 offset:512
    ds_read_b64_tr_b16 v[46:47], v239 offset:768
    ds_read_b64_tr_b16 v[48:49], v240 offset:8192
    ds_read_b64_tr_b16 v[50:51], v240 offset:10240
    ds_read_b64_tr_b16 v[52:53], v241 offset:8192
    ds_read_b64_tr_b16 v[54:55], v241 offset:10240
    ds_read_b64_tr_b16 v[56:57], v242 offset:8192
    ds_read_b64_tr_b16 v[58:59], v242 offset:10240
    ds_read_b64_tr_b16 v[60:61], v243 offset:8192
    ds_read_b64_tr_b16 v[62:63], v243 offset:10240
    ds_read_b64_tr_b16 v[64:65], v240 offset:12288
    ds_read_b64_tr_b16 v[66:67], v240 offset:14336
    ds_read_b64_tr_b16 v[68:69], v241 offset:12288
    ds_read_b64_tr_b16 v[70:71], v241 offset:14336
    ds_read_b64_tr_b16 v[72:73], v242 offset:12288
    ds_read_b64_tr_b16 v[74:75], v242 offset:14336
    ds_read_b64_tr_b16 v[76:77], v243 offset:12288
    ds_read_b64_tr_b16 v[78:79], v243 offset:14336
    s_waitcnt lgkmcnt(0)
    s_barrier
    s_cmp_eq_u32 s3, s70
    s_cbranch_scc0 L_nomlp1
    v_lshrrev_b32 v4, 2, v1
    v_lshlrev_b32 v4, 10, v4
    v_lshl_add_u32 v4, v2, 4, v4
    s_lshl_b32 s4, s69, 7
    v_add_u32 v4, s4, v4
    ds_read_b128 v[80:83], v4 offset:8192
    ds_read_b128 v[84:87], v4 offset:8256
    s_lshl_b32 s14, s68, 3
    s_add_u32 s14, s14, s69
    s_mul_i32 s14, s14, 1536
    s_add_u32 s14, s14, 458752
    v_lshlrev_b32 v4, 6, v2
    v_lshl_add_u32 v4, v1, 2, v4
    s_mov_b32 s8, 0x11111111
    s_mov_b32 s9, 0x11111111
    s_waitcnt lgkmcnt(0)
    v_lshlrev_b32 v96, 16, v80
    v_and_b32 v97, 0xffff0000, v80
    v_lshlrev_b32 v98, 16, v81
    v_and_b32 v99, 0xffff0000, v81
    v_lshlrev_b32 v100, 16, v82
    v_and_b32 v101, 0xffff0000, v82
    v_lshlrev_b32 v102, 16, v83
    v_and_b32 v103, 0xffff0000, v83
    v_lshlrev_b32 v104, 16, v84
    v_and_b32 v105, 0xffff0000, v84
    v_lshlrev_b32 v106, 16, v85
    v_and_b32 v107, 0xffff0000, v85
    v_lshlrev_b32 v108, 16, v86
    v_and_b32 v109, 0xffff0000, v86
    v_lshlrev_b32 v110, 16, v87
    v_and_b32 v111, 0xffff0000, v87
    v_sub_f32 v96, v96, v252
    v_sub_f32 v97, v97, v252
    v_sub_f32 v98, v98, v252
    v_sub_f32 v99, v99, v252
    v_sub_f32 v100, v100, v252
    v_sub_f32 v101, v101, v252
    v_sub_f32 v102, v102, v252
    v_sub_f32 v103, v103, v252
    v_sub_f32 v104, v104, v252
    v_sub_f32 v105, v105, v252
    v_sub_f32 v106, v106, v252
    v_sub_f32 v107, v107, v252
    v_sub_f32 v108, v108, v252
    v_sub_f32 v109, v109, v252
    v_sub_f32 v110, v110, v252
    v_sub_f32 v111, v111, v252
    v_cvt_pk_bf16_f32 v80, v96, v97
    v_cvt_pk_bf16_f32 v81, v98, v99
    v_cvt_pk_bf16_f32 v82, v100, v101
    v_cvt_pk_bf16_f32 v83, v102, v103
    v_cvt_pk_bf16_f32 v84, v104, v105
    v_cvt_pk_bf16_f32 v85, v106, v107
    v_cvt_pk_bf16_f32 v86, v108, v109
    v_cvt_pk_bf16_f32 v87, v110, v111
    v_lshlrev_b32 v96, 16, v80
    v_and_b32 v97, 0xffff0000, v80
    v_lshlrev_b32 v98, 16, v81
    v_and_b32 v99, 0xffff0000, v81
    v_lshlrev_b32 v100, 16, v82
    v_and_b32 v101, 0xffff0000, v82
    v_lshlrev_b32 v102, 16, v83
    v_and_b32 v103, 0xffff0000, v83
    v_lshlrev_b32 v104, 16, v84
    v_and_b32 v105, 0xffff0000, v84
    v_lshlrev_b32 v106, 16, v85
    v_and_b32 v107, 0xffff0000, v85
    v_lshlrev_b32 v108, 16, v86
    v_and_b32 v109, 0xffff0000, v86
    v_lshlrev_b32 v110, 16, v87
    v_and_b32 v111, 0xffff0000, v87
    v_mul_f32 v96, v96, v253
    v_mul_f32 v97, v97, v253
    v_mul_f32 v98, v98, v253
    v_mul_f32 v99, v99, v253
    v_mul_f32 v100, v100, v253
    v_mul_f32 v101, v101, v253
    v_mul_f32 v102, v102, v253
    v_mul_f32 v103, v103, v253
    v_mul_f32 v104, v104, v253
    v_mul_f32 v105, v105, v253
    v_mul_f32 v106, v106, v253
    v_mul_f32 v107, v107, v253
    v_mul_f32 v108, v108, v253
    v_mul_f32 v109, v109, v253
    v_mul_f32 v110, v110, v253
    v_mul_f32 v111, v111, v253
    v_cvt_pk_bf16_f32 v80, v96, v97
    v_cvt_pk_bf16_f32 v81, v98, v99
    v_cvt_pk_bf16_f32 v82, v100, v101
    v_cvt_pk_bf16_f32 v83, v102, v103
    v_cvt_pk_bf16_f32 v84, v104, v105
    v_cvt_pk_bf16_f32 v85, v106, v107
    v_cvt_pk_bf16_f32 v86, v108, v109
    v_cvt_pk_bf16_f32 v87, v110, v111
    s_waitcnt vmcnt(8)
    v_perm_b32 v96, v172, v168, s10
    v_perm_b32 v97, v180, v176, s10
    v_perm_b32 v98, v188, v184, s10
    v_perm_b32 v99, v196, v192, s10
    v_perm_b32 v100, v172, v168, s11
    v_perm_b32 v101, v180, v176, s11
    v_perm_b32 v102, v188, v184, s11
    v_perm_b32 v103, v196, v192, s11
    v_perm_b32 v104, v173, v169, s10
    v_perm_b32 v105, v181, v177, s10
    v_perm_b32 v106, v189, v185, s10
    v_perm_b32 v107, v197, v193, s10
    v_perm_b32 v108, v173, v169, s11
    v_perm_b32 v109, v181, v177, s11
    v_perm_b32 v110, v189, v185, s11
    v_perm_b32 v111, v197, v193, s11
    v_perm_b32 v112, v174, v170, s10
    v_perm_b32 v113, v182, v178, s10
    v_perm_b32 v114, v190, v186, s10
    v_perm_b32 v115, v198, v194, s10
    v_perm_b32 v116, v174, v170, s11
    v_perm_b32 v117, v182, v178, s11
    v_perm_b32 v118, v190, v186, s11
    v_perm_b32 v119, v198, v194, s11
    v_perm_b32 v120, v175, v171, s10
    v_perm_b32 v121, v183, v179, s10
    v_perm_b32 v122, v191, v187, s10
    v_perm_b32 v123, v199, v195, s10
    v_perm_b32 v124, v175, v171, s11
    v_perm_b32 v125, v183, v179, s11
    v_perm_b32 v126, v191, v187, s11
    v_perm_b32 v127, v199, v195, s11
    v_mfma_f32_16x16x32_bf16 v[128:131], v[96:99], v[80:83], 0
    v_mfma_f32_16x16x32_bf16 v[132:135], v[100:103], v[80:83], 0
    v_mfma_f32_16x16x32_bf16 v[136:139], v[104:107], v[80:83], 0
    v_mfma_f32_16x16x32_bf16 v[140:143], v[108:111], v[80:83], 0
    v_mfma_f32_16x16x32_bf16 v[144:147], v[112:115], v[80:83], 0
    v_mfma_f32_16x16x32_bf16 v[148:151], v[116:119], v[80:83], 0
    v_mfma_f32_16x16x32_bf16 v[152:155], v[120:123], v[80:83], 0
    v_mfma_f32_16x16x32_bf16 v[156:159], v[124:127], v[80:83], 0
    s_waitcnt vmcnt(0)
    v_perm_b32 v96, v204, v200, s10
    v_perm_b32 v97, v212, v208, s10
    v_perm_b32 v98, v220, v216, s10
    v_perm_b32 v99, v228, v224, s10
    v_perm_b32 v100, v204, v200, s11
    v_perm_b32 v101, v212, v208, s11
    v_perm_b32 v102, v220, v216, s11
    v_perm_b32 v103, v228, v224, s11
    v_perm_b32 v104, v205, v201, s10
    v_perm_b32 v105, v213, v209, s10
    v_perm_b32 v106, v221, v217, s10
    v_perm_b32 v107, v229, v225, s10
    v_perm_b32 v108, v205, v201, s11
    v_perm_b32 v109, v213, v209, s11
    v_perm_b32 v110, v221, v217, s11
    v_perm_b32 v111, v229, v225, s11
    v_perm_b32 v112, v206, v202, s10
    v_perm_b32 v113, v214, v210, s10
    v_perm_b32 v114, v222, v218, s10
    v_perm_b32 v115, v230, v226, s10
    v_perm_b32 v116, v206, v202, s11
    v_perm_b32 v117, v214, v210, s11
    v_perm_b32 v118, v222, v218, s11
    v_perm_b32 v119, v230, v226, s11
    v_perm_b32 v120, v207, v203, s10
    v_perm_b32 v121, v215, v211, s10
    v_perm_b32 v122, v223, v219, s10
    v_perm_b32 v123, v231, v227, s10
    v_perm_b32 v124, v207, v203, s11
    v_perm_b32 v125, v215, v211, s11
    v_perm_b32 v126, v223, v219, s11
    v_perm_b32 v127, v231, v227, s11
    v_mfma_f32_16x16x32_bf16 v[128:131], v[96:99], v[84:87], v[128:131]
    v_mfma_f32_16x16x32_bf16 v[132:135], v[100:103], v[84:87], v[132:135]
    v_mfma_f32_16x16x32_bf16 v[136:139], v[104:107], v[84:87], v[136:139]
    v_mfma_f32_16x16x32_bf16 v[140:143], v[108:111], v[84:87], v[140:143]
    v_mfma_f32_16x16x32_bf16 v[144:147], v[112:115], v[84:87], v[144:147]
    v_mfma_f32_16x16x32_bf16 v[148:151], v[116:119], v[84:87], v[148:151]
    v_mfma_f32_16x16x32_bf16 v[152:155], v[120:123], v[84:87], v[152:155]
    v_mfma_f32_16x16x32_bf16 v[156:159], v[124:127], v[84:87], v[156:159]
    v_mov_b32 v171, s12
    v_mov_b32 v175, s12
    v_mov_b32 v179, s12
    v_mov_b32 v183, s12
    v_mov_b32 v187, s12
    v_mov_b32 v191, s12
    v_cvt_pk_bf16_f32 v168, v128, v132
    v_cvt_pk_bf16_f32 v169, v136, v140
    v_cvt_pk_bf16_f32 v170, v144, v148
    v_cvt_pk_bf16_f32 v184, v152, v156
    v_cvt_pk_bf16_f32 v172, v129, v133
    v_cvt_pk_bf16_f32 v173, v137, v141
    v_cvt_pk_bf16_f32 v174, v145, v149
    v_cvt_pk_bf16_f32 v185, v153, v157
    v_cvt_pk_bf16_f32 v176, v130, v134
    v_cvt_pk_bf16_f32 v177, v138, v142
    v_cvt_pk_bf16_f32 v178, v146, v150
    v_cvt_pk_bf16_f32 v186, v154, v158
    v_cvt_pk_bf16_f32 v180, v131, v135
    v_cvt_pk_bf16_f32 v181, v139, v143
    v_cvt_pk_bf16_f32 v182, v147, v151
    v_cvt_pk_bf16_f32 v188, v155, v159
    s_mov_b64 exec, s[8:9]
    buffer_store_dwordx4 v[168:171], v4, s[44:47], s14 offen offset:0 sc1
    buffer_store_dwordx4 v[172:175], v4, s[44:47], s14 offen offset:256 sc1
    buffer_store_dwordx4 v[176:179], v4, s[44:47], s14 offen offset:512 sc1
    buffer_store_dwordx4 v[180:183], v4, s[44:47], s14 offen offset:768 sc1
    buffer_store_dwordx4 v[184:187], v4, s[44:47], s14 offen offset:1024 sc1
    buffer_store_dwordx4 v[188:191], v4, s[44:47], s14 offen offset:1280 sc1
    s_mov_b64 exec, -1
    s_nop 0
L_nomlp1:
    s_cmp_lt_u32 s3, 6
    s_cbranch_scc1 L_nohsp
    s_mov_b32 s13, 0
L_poll7:
    buffer_load_dwordx4 v[160:163], v13, s[44:47], s5 offen sc1
    s_waitcnt vmcnt(0)
L_chk8:
    v_xor_b32 v14, s12, v163
    v_cmp_ne_u32 vcc, 0, v14
    s_nop 3
    s_cbranch_vccz L_done9
    s_mov_b64 exec, vcc
    s_add_u32 s13, s13, 1
    s_cmp_ge_u32 s13, 100000
    s_cbranch_scc1 L_done9
    s_sleep 2
    s_branch L_poll7
L_done9:
    s_mov_b64 exec, -1
    ds_write_b128 v164, v[160:163] offset:6144
    s_waitcnt lgkmcnt(0)
L_nohsp:
    s_barrier
    s_sleep 6
    s_mov_b32 m0, s20
    s_nop 0
    buffer_load_dwordx4 v12, s[44:47], s18 offen offset:0 sc1 lds
    buffer_load_dwordx4 v12, s[44:47], s18 offen offset:1024 sc1 lds
    buffer_load_dwordx4 v12, s[44:47], s18 offen offset:2048 sc1 lds
    buffer_load_dwordx4 v12, s[44:47], s18 offen offset:3072 sc1 lds
    s_mov_b32 m0, s21
    s_nop 0
    buffer_load_dwordx4 v12, s[44:47], s19 offen offset:0 sc1 lds
    buffer_load_dwordx4 v12, s[44:47], s19 offen offset:1024 sc1 lds
    buffer_load_dwordx4 v12, s[44:47], s19 offen offset:2048 sc1 lds
    buffer_load_dwordx4 v12, s[44:47], s19 offen offset:3072 sc1 lds
    ds_read_b128 v[80:83], v15 offset:6144
    ds_read_b128 v[84:87], v15 offset:7168
    s_waitcnt lgkmcnt(0)
    v_mov_b32 v88, v80
    v_mov_b32 v89, v84
    s_nop 0
    v_max_f32_dpp v88, v88, v88 quad_perm:[1,0,3,2] row_mask:0xf bank_mask:0xf
    v_max_f32_dpp v89, v89, v89 quad_perm:[1,0,3,2] row_mask:0xf bank_mask:0xf
    s_nop 0
    v_max_f32_dpp v88, v88, v88 quad_perm:[2,3,0,1] row_mask:0xf bank_mask:0xf
    v_max_f32_dpp v89, v89, v89 quad_perm:[2,3,0,1] row_mask:0xf bank_mask:0xf
    s_nop 0
    v_max_f32_dpp v88, v88, v88 row_ror:8 row_mask:0xf bank_mask:0xf
    v_max_f32_dpp v89, v89, v89 row_ror:8 row_mask:0xf bank_mask:0xf
    v_mov_b32 v90, v88
    v_mov_b32 v91, v89
    s_nop 0
    v_permlane16_swap_b32 v88, v90
    v_permlane16_swap_b32 v89, v91
    v_max_f32 v88, v88, v90
    v_max_f32 v89, v89, v91
    v_mov_b32 v90, v88
    v_mov_b32 v91, v89
    s_nop 0
    v_permlane32_swap_b32 v88, v90
    v_permlane32_swap_b32 v89, v91
    v_max_f32 v88, v88, v90
    v_max_f32 v89, v89, v91
    v_sub_f32 v80, v80, v88
    v_sub_f32 v84, v84, v89
    v_exp_f32 v80, v80
    v_exp_f32 v84, v84
    s_nop 0
    v_cvt_pk_bf16_f32 v82, v80, v84
    v_lshlrev_b32 v80, 16, v82
    v_and_b32 v84, 0xffff0000, v82
    ds_write_b32 v8, v80
    ds_write_b32 v8, v84 offset:256
    v_mul_f32 v88, v80, v81
    v_mul_f32 v89, v84, v85
    s_nop 0
    v_add_f32_dpp v88, v88, v88 quad_perm:[1,0,3,2] row_mask:0xf bank_mask:0xf
    v_add_f32_dpp v89, v89, v89 quad_perm:[1,0,3,2] row_mask:0xf bank_mask:0xf
    s_nop 0
    v_add_f32_dpp v88, v88, v88 quad_perm:[2,3,0,1] row_mask:0xf bank_mask:0xf
    v_add_f32_dpp v89, v89, v89 quad_perm:[2,3,0,1] row_mask:0xf bank_mask:0xf
    s_nop 0
    v_add_f32_dpp v88, v88, v88 row_ror:8 row_mask:0xf bank_mask:0xf
    v_add_f32_dpp v89, v89, v89 row_ror:8 row_mask:0xf bank_mask:0xf
    v_mov_b32 v90, v88
    v_mov_b32 v91, v89
    s_nop 0
    v_permlane16_swap_b32 v88, v90
    v_permlane16_swap_b32 v89, v91
    v_add_f32 v88, v88, v90
    v_add_f32 v89, v89, v91
    v_mov_b32 v90, v88
    v_mov_b32 v91, v89
    s_nop 0
    v_permlane32_swap_b32 v88, v90
    v_permlane32_swap_b32 v89, v91
    v_add_f32 v88, v88, v90
    v_add_f32 v89, v89, v91
    s_waitcnt lgkmcnt(0)
    ds_read_b32 v96, v9 offset:0
    ds_read_b32 v97, v9 offset:32
    ds_read_b32 v98, v9 offset:64
    ds_read_b32 v99, v9 offset:96
    ds_read_b32 v100, v9 offset:8
    ds_read_b32 v101, v9 offset:40
    ds_read_b32 v102, v9 offset:72
    ds_read_b32 v103, v9 offset:104
    v_and_b32 v3, 1, v1
    v_cmp_eq_u32 vcc, 1, v3
    s_nop 1
    v_cndmask_b32 v88, v88, v89, vcc
    v_rcp_f32 v88, v88
    s_waitcnt lgkmcnt(0)
    v_perm_b32 v92, v97, v96, s11
    v_perm_b32 v93, v99, v98, s11
    v_perm_b32 v94, v101, v100, s11
    v_perm_b32 v95, v103, v102, s11
    v_cndmask_b32 v84, 0, v92, vcc
    v_cndmask_b32 v85, 0, v93, vcc
    v_cndmask_b32 v86, 0, v94, vcc
    v_cndmask_b32 v87, 0, v95, vcc
    v_cndmask_b32 v80, v92, 0, vcc
    v_cndmask_b32 v81, v93, 0, vcc
    v_cndmask_b32 v82, v94, 0, vcc
    v_cndmask_b32 v83, v95, 0, vcc
    s_mov_b32 s13, 0
    s_nop 0
L_pv10:
    s_waitcnt vmcnt(0)
    ds_read_b128 v[128:131], v165 offset:0
    ds_read_b128 v[132:135], v165 offset:1024
    ds_read_b128 v[136:139], v165 offset:2048
    ds_read_b128 v[140:143], v165 offset:3072
    ds_read_b128 v[144:147], v165 offset:4096
    ds_read_b128 v[148:151], v165 offset:5120
    ds_read_b128 v[152:155], v165 offset:6144
    ds_read_b128 v[156:159], v165 offset:7168
    s_waitcnt lgkmcnt(7)
    v_xor_b32 v96, v128, v248
    v_bitop3_b32 v96, v96, v129, v249 bitop3:0xf6
    v_bitop3_b32 v96, v96, v130, v250 bitop3:0xf6
    v_bitop3_b32 v96, v96, v131, v251 bitop3:0xf6
    s_waitcnt lgkmcnt(6)
    v_xor_b32 v97, v132, v248
    v_bitop3_b32 v97, v97, v133, v249 bitop3:0xf6
    v_bitop3_b32 v97, v97, v134, v250 bitop3:0xf6
    v_bitop3_b32 v97, v97, v135, v251 bitop3:0xf6
    s_waitcnt lgkmcnt(5)
    v_xor_b32 v98, v136, v248
    v_bitop3_b32 v98, v98, v137, v249 bitop3:0xf6
    v_bitop3_b32 v98, v98, v138, v250 bitop3:0xf6
    v_bitop3_b32 v98, v98, v139, v251 bitop3:0xf6
    s_waitcnt lgkmcnt(4)
    v_xor_b32 v99, v140, v248
    v_bitop3_b32 v99, v99, v141, v249 bitop3:0xf6
    v_bitop3_b32 v99, v99, v142, v250 bitop3:0xf6
    v_bitop3_b32 v99, v99, v143, v251 bitop3:0xf6
    s_waitcnt lgkmcnt(3)
    v_xor_b32 v100, v144, v248
    v_bitop3_b32 v100, v100, v145, v249 bitop3:0xf6
    v_bitop3_b32 v100, v100, v146, v250 bitop3:0xf6
    v_bitop3_b32 v100, v100, v147, v251 bitop3:0xf6
    s_waitcnt lgkmcnt(2)
    v_xor_b32 v101, v148, v248
    v_bitop3_b32 v101, v101, v149, v249 bitop3:0xf6
    v_bitop3_b32 v101, v101, v150, v250 bitop3:0xf6
    v_bitop3_b32 v101, v101, v151, v251 bitop3:0xf6
    s_waitcnt lgkmcnt(1)
    v_xor_b32 v102, v152, v248
    v_bitop3_b32 v102, v102, v153, v249 bitop3:0xf6
    v_bitop3_b32 v102, v102, v154, v250 bitop3:0xf6
    v_bitop3_b32 v102, v102, v155, v251 bitop3:0xf6
    s_waitcnt lgkmcnt(0)
    v_xor_b32 v103, v156, v248
    v_bitop3_b32 v103, v103, v157, v249 bitop3:0xf6
    v_bitop3_b32 v103, v103, v158, v250 bitop3:0xf6
    v_bitop3_b32 v103, v103, v159, v251 bitop3:0xf6
    v_or3_b32 v104, v96, v97, v98
    v_or3_b32 v105, v99, v100, v101
    v_or3_b32 v104, v104, v102, v103
    v_bitop3_b32 v104, v104, v105, v166 bitop3:0xa8
    v_cmp_ne_u32 vcc, 0, v104
    s_nop 3
    s_cbranch_vccz L_pvd11
    s_add_u32 s13, s13, 1
    s_cmp_ge_u32 s13, 100000
    s_cbranch_scc1 L_pvd11
    s_sleep 1
    v_and_b32 v96, v166, v96
    s_nop 1
    v_or_b32_dpp v96, v96, v96 quad_perm:[1,0,3,2] row_mask:0xf bank_mask:0xf
    s_nop 1
    v_or_b32_dpp v96, v96, v96 quad_perm:[2,3,0,1] row_mask:0xf bank_mask:0xf
    s_nop 1
    v_or_b32_dpp v96, v96, v96 row_half_mirror row_mask:0xf bank_mask:0xf
    v_cmp_ne_u32 vcc, 0, v96
    s_nop 3
    s_cbranch_vccz L_pr12
    s_add_u32 m0, s63, 0
    s_mov_b64 exec, vcc
    buffer_load_dwordx4 v12, s[44:47], s6 offen offset:0 sc1 lds
    s_mov_b64 exec, -1
L_pr12:
    v_and_b32 v97, v166, v97
    s_nop 1
    v_or_b32_dpp v97, v97, v97 quad_perm:[1,0,3,2] row_mask:0xf bank_mask:0xf
    s_nop 1
    v_or_b32_dpp v97, v97, v97 quad_perm:[2,3,0,1] row_mask:0xf bank_mask:0xf
    s_nop 1
    v_or_b32_dpp v97, v97, v97 row_half_mirror row_mask:0xf bank_mask:0xf
    v_cmp_ne_u32 vcc, 0, v97
    s_nop 3
    s_cbranch_vccz L_pr13
    s_add_u32 m0, s63, 0
    s_mov_b64 exec, vcc
    buffer_load_dwordx4 v12, s[44:47], s6 offen offset:1024 sc1 lds
    s_mov_b64 exec, -1
L_pr13:
    v_and_b32 v98, v166, v98
    s_nop 1
    v_or_b32_dpp v98, v98, v98 quad_perm:[1,0,3,2] row_mask:0xf bank_mask:0xf
    s_nop 1
    v_or_b32_dpp v98, v98, v98 quad_perm:[2,3,0,1] row_mask:0xf bank_mask:0xf
    s_nop 1
    v_or_b32_dpp v98, v98, v98 row_half_mirror row_mask:0xf bank_mask:0xf
    v_cmp_ne_u32 vcc, 0, v98
    s_nop 3
    s_cbranch_vccz L_pr14
    s_add_u32 m0, s63, 0
    s_mov_b64 exec, vcc
    buffer_load_dwordx4 v12, s[44:47], s6 offen offset:2048 sc1 lds
    s_mov_b64 exec, -1
L_pr14:
    v_and_b32 v99, v166, v99
    s_nop 1
    v_or_b32_dpp v99, v99, v99 quad_perm:[1,0,3,2] row_mask:0xf bank_mask:0xf
    s_nop 1
    v_or_b32_dpp v99, v99, v99 quad_perm:[2,3,0,1] row_mask:0xf bank_mask:0xf
    s_nop 1
    v_or_b32_dpp v99, v99, v99 row_half_mirror row_mask:0xf bank_mask:0xf
    v_cmp_ne_u32 vcc, 0, v99
    s_nop 3
    s_cbranch_vccz L_pr15
    s_add_u32 m0, s63, 0
    s_mov_b64 exec, vcc
    buffer_load_dwordx4 v12, s[44:47], s6 offen offset:3072 sc1 lds
    s_mov_b64 exec, -1
L_pr15:
    v_and_b32 v100, v166, v100
    s_nop 1
    v_or_b32_dpp v100, v100, v100 quad_perm:[1,0,3,2] row_mask:0xf bank_mask:0xf
    s_nop 1
    v_or_b32_dpp v100, v100, v100 quad_perm:[2,3,0,1] row_mask:0xf bank_mask:0xf
    s_nop 1
    v_or_b32_dpp v100, v100, v100 row_half_mirror row_mask:0xf bank_mask:0xf
    v_cmp_ne_u32 vcc, 0, v100
    s_nop 3
    s_cbranch_vccz L_pr16
    s_add_u32 m0, s63, 4096
    s_mov_b64 exec, vcc
    buffer_load_dwordx4 v12, s[44:47], s7 offen offset:0 sc1 lds
    s_mov_b64 exec, -1
L_pr16:
    v_and_b32 v101, v166, v101
    s_nop 1
    v_or_b32_dpp v101, v101, v101 quad_perm:[1,0,3,2] row_mask:0xf bank_mask:0xf
    s_nop 1
    v_or_b32_dpp v101, v101, v101 quad_perm:[2,3,0,1] row_mask:0xf bank_mask:0xf
    s_nop 1
    v_or_b32_dpp v101, v101, v101 row_half_mirror row_mask:0xf bank_mask:0xf
    v_cmp_ne_u32 vcc, 0, v101
    s_nop 3
    s_cbranch_vccz L_pr17
    s_add_u32 m0, s63, 4096
    s_mov_b64 exec, vcc
    buffer_load_dwordx4 v12, s[44:47], s7 offen offset:1024 sc1 lds
    s_mov_b64 exec, -1
L_pr17:
    v_and_b32 v102, v166, v102
    s_nop 1
    v_or_b32_dpp v102, v102, v102 quad_perm:[1,0,3,2] row_mask:0xf bank_mask:0xf
    s_nop 1
    v_or_b32_dpp v102, v102, v102 quad_perm:[2,3,0,1] row_mask:0xf bank_mask:0xf
    s_nop 1
    v_or_b32_dpp v102, v102, v102 row_half_mirror row_mask:0xf bank_mask:0xf
    v_cmp_ne_u32 vcc, 0, v102
    s_nop 3
    s_cbranch_vccz L_pr18
    s_add_u32 m0, s63, 4096
    s_mov_b64 exec, vcc
    buffer_load_dwordx4 v12, s[44:47], s7 offen offset:2048 sc1 lds
    s_mov_b64 exec, -1
L_pr18:
    v_and_b32 v103, v166, v103
    s_nop 1
    v_or_b32_dpp v103, v103, v103 quad_perm:[1,0,3,2] row_mask:0xf bank_mask:0xf
    s_nop 1
    v_or_b32_dpp v103, v103, v103 quad_perm:[2,3,0,1] row_mask:0xf bank_mask:0xf
    s_nop 1
    v_or_b32_dpp v103, v103, v103 row_half_mirror row_mask:0xf bank_mask:0xf
    v_cmp_ne_u32 vcc, 0, v103
    s_nop 3
    s_cbranch_vccz L_pr19
    s_add_u32 m0, s63, 4096
    s_mov_b64 exec, vcc
    buffer_load_dwordx4 v12, s[44:47], s7 offen offset:3072 sc1 lds
    s_mov_b64 exec, -1
L_pr19:
    s_branch L_pv10
L_pvd11:
    ds_read_b64_tr_b16 v[128:129], v240 offset:0
    ds_read_b64_tr_b16 v[130:131], v240 offset:2048
    ds_read_b64_tr_b16 v[132:133], v241 offset:0
    ds_read_b64_tr_b16 v[134:135], v241 offset:2048
    ds_read_b64_tr_b16 v[136:137], v242 offset:0
    ds_read_b64_tr_b16 v[138:139], v242 offset:2048
    ds_read_b64_tr_b16 v[140:141], v243 offset:0
    ds_read_b64_tr_b16 v[142:143], v243 offset:2048
    ds_read_b64_tr_b16 v[144:145], v240 offset:4096
    ds_read_b64_tr_b16 v[146:147], v240 offset:6144
    ds_read_b64_tr_b16 v[148:149], v241 offset:4096
    ds_read_b64_tr_b16 v[150:151], v241 offset:6144
    ds_read_b64_tr_b16 v[152:153], v242 offset:4096
    ds_read_b64_tr_b16 v[154:155], v242 offset:6144
    ds_read_b64_tr_b16 v[156:157], v243 offset:4096
    ds_read_b64_tr_b16 v[158:159], v243 offset:6144
    s_waitcnt lgkmcnt(8)
    v_mfma_f32_16x16x32_bf16 v[96:99], v[128:131], v[80:83], 0
    v_mfma_f32_16x16x32_bf16 v[100:103], v[132:135], v[80:83], 0
    v_mfma_f32_16x16x32_bf16 v[104:107], v[136:139], v[80:83], 0
    v_mfma_f32_16x16x32_bf16 v[108:111], v[140:143], v[80:83], 0
    s_waitcnt lgkmcnt(0)
    v_mfma_f32_16x16x32_bf16 v[96:99], v[144:147], v[84:87], v[96:99]
    v_mfma_f32_16x16x32_bf16 v[100:103], v[148:151], v[84:87], v[100:103]
    v_mfma_f32_16x16x32_bf16 v[104:107], v[152:155], v[84:87], v[104:107]
    v_mfma_f32_16x16x32_bf16 v[108:111], v[156:159], v[84:87], v[108:111]
    s_mov_b32 s8, 0x00030003
    s_mov_b32 s9, 0x00030003
    s_nop 2
    v_mul_f32 v96, v96, v88
    v_mul_f32 v97, v97, v88
    v_mul_f32 v98, v98, v88
    v_mul_f32 v99, v99, v88
    v_mul_f32 v100, v100, v88
    v_mul_f32 v101, v101, v88
    v_mul_f32 v102, v102, v88
    v_mul_f32 v103, v103, v88
    v_mul_f32 v104, v104, v88
    v_mul_f32 v105, v105, v88
    v_mul_f32 v106, v106, v88
    v_mul_f32 v107, v107, v88
    v_mul_f32 v108, v108, v88
    v_mul_f32 v109, v109, v88
    v_mul_f32 v110, v110, v88
    v_mul_f32 v111, v111, v88
    v_cvt_pk_bf16_f32 v80, v96, v97
    v_cvt_pk_bf16_f32 v81, v98, v99
    v_cvt_pk_bf16_f32 v82, v100, v101
    v_cvt_pk_bf16_f32 v83, v102, v103
    v_cvt_pk_bf16_f32 v84, v104, v105
    v_cvt_pk_bf16_f32 v85, v106, v107
    v_cvt_pk_bf16_f32 v86, v108, v109
    v_cvt_pk_bf16_f32 v87, v110, v111
    v_mfma_f32_16x16x32_bf16 v[104:107], v[16:19], v[80:83], 0
    v_mfma_f32_16x16x32_bf16 v[108:111], v[20:23], v[80:83], 0
    v_mfma_f32_16x16x32_bf16 v[112:115], v[24:27], v[80:83], 0
    v_mfma_f32_16x16x32_bf16 v[116:119], v[28:31], v[80:83], 0
    v_mfma_f32_16x16x32_bf16 v[104:107], v[32:35], v[84:87], v[104:107]
    v_mfma_f32_16x16x32_bf16 v[108:111], v[36:39], v[84:87], v[108:111]
    v_mfma_f32_16x16x32_bf16 v[112:115], v[40:43], v[84:87], v[112:115]
    v_mfma_f32_16x16x32_bf16 v[116:119], v[44:47], v[84:87], v[116:119]
    s_nop 4
    v_cvt_pk_bf16_f32 v120, v104, v105
    v_cvt_pk_bf16_f32 v121, v106, v107
    v_cvt_pk_bf16_f32 v122, v108, v109
    v_cvt_pk_bf16_f32 v123, v110, v111
    v_cvt_pk_bf16_f32 v124, v112, v113
    v_cvt_pk_bf16_f32 v125, v114, v115
    v_cvt_pk_bf16_f32 v126, v116, v117
    v_cvt_pk_bf16_f32 v127, v118, v119
    s_mov_b64 exec, s[8:9]
    ds_write_b128 v10, v[120:123] offset:0
    ds_write_b128 v10, v[124:127] offset:1024
    s_mov_b64 exec, -1
    s_waitcnt lgkmcnt(0)
    s_barrier
    ds_read_b128 v[96:99], v15 offset:4096
    ds_read_b128 v[100:103], v15 offset:5120
    s_waitcnt lgkmcnt(1)
    v_mfma_f32_16x16x32_bf16 v[104:107], v[96:99], v[48:51], 0
    v_mfma_f32_16x16x32_bf16 v[108:111], v[96:99], v[52:55], 0
    v_mfma_f32_16x16x32_bf16 v[112:115], v[96:99], v[56:59], 0
    v_mfma_f32_16x16x32_bf16 v[116:119], v[96:99], v[60:63], 0
    s_waitcnt lgkmcnt(0)
    v_mfma_f32_16x16x32_bf16 v[104:107], v[100:103], v[64:67], v[104:107]
    v_mfma_f32_16x16x32_bf16 v[108:111], v[100:103], v[68:71], v[108:111]
    v_mfma_f32_16x16x32_bf16 v[112:115], v[100:103], v[72:75], v[112:115]
    v_mfma_f32_16x16x32_bf16 v[116:119], v[100:103], v[76:79], v[116:119]
    s_nop 4
    v_add_f32 v104, v104, v106
    v_add_f32 v105, v105, v107
    v_add_f32 v108, v108, v110
    v_add_f32 v109, v109, v111
    v_add_f32 v112, v112, v114
    v_add_f32 v113, v113, v115
    v_add_f32 v116, v116, v118
    v_add_f32 v117, v117, v119
    v_permlane32_swap_b32 v104, v105
    v_permlane32_swap_b32 v108, v109
    v_permlane32_swap_b32 v112, v113
    v_permlane32_swap_b32 v116, v117
    v_add_f32 v104, v104, v105
    v_add_f32 v108, v108, v109
    v_add_f32 v112, v112, v113
    v_add_f32 v116, v116, v117
    v_mov_b32 v105, v104
    v_mov_b32 v109, v108
    v_mov_b32 v113, v112
    v_mov_b32 v117, v116
    v_permlane16_swap_b32 v104, v105
    v_permlane16_swap_b32 v108, v109
    v_permlane16_swap_b32 v112, v113
    v_permlane16_swap_b32 v116, v117
    v_add_f32 v104, v104, v105
    v_add_f32 v108, v108, v109
    v_add_f32 v112, v112, v113
    v_add_f32 v116, v116, v117
    v_cvt_pk_bf16_f32 v244, v104, v108
    v_cvt_pk_bf16_f32 v245, v112, v116
    s_mov_b32 s8, 0x0000ffff
    s_mov_b32 s9, 0x0000ffff
    s_mov_b64 exec, s[8:9]
    buffer_store_dwordx4 v[244:247], v7, s[44:47], s71 offen sc1
    s_mov_b64 exec, -1
    s_cmp_lt_u32 s3, 2
    s_cbranch_scc1 L_final
    s_cmp_lg_u32 s2, 8
    s_cbranch_scc1 L_wend
    s_cmp_lg_u32 s3, 2
    s_cbranch_scc1 L_wend
    v_lshlrev_b32 v12, 11, v0
    s_mov_b32 s6, 1310720
    s_mov_b32 s7, 1630208
    s_mov_b32 s13, 0
L_poll20:
    buffer_load_dwordx4 v[16:19], v12, s[44:47], s6 offen sc1
    buffer_load_dwordx4 v[20:23], v12, s[44:47], s7 offen sc1
    s_waitcnt vmcnt(0)
L_chk21:
    v_xor_b32 v14, s12, v19
    v_bitop3_b32 v14, v14, v23, s12 bitop3:0xf6
    v_cmp_ne_u32 vcc, 0, v14
    s_nop 3
    s_cbranch_vccz L_done22
    s_mov_b64 exec, vcc
    s_add_u32 s13, s13, 1
    s_cmp_ge_u32 s13, 100000
    s_cbranch_scc1 L_done22
    s_sleep 1
    s_branch L_poll20
L_done22:
    s_mov_b64 exec, -1
    s_mov_b64 exec, 1
    v_mov_b32 v5, 0
    v_mov_b32 v6, s12
    buffer_store_dword v6, v5, s[44:47], 0 offen
    s_nop 0
L_wend:
    s_endpgm
L_final:
    s_mov_b32 s48, s16
    s_and_b32 s49, s17, 0xffff
    s_mov_b32 s50, 4096
    s_mov_b32 s51, 0x20000
    s_mov_b32 s52, s36
    s_and_b32 s53, s37, 0xffff
    s_mov_b32 s54, 1024
    s_mov_b32 s55, 0x20000
    s_mov_b32 s56, s38
    s_and_b32 s57, s39, 0xffff
    s_mov_b32 s58, 4096
    s_mov_b32 s59, 0x20000
    s_and_b32 s5, s60, 1
    s_lshl_b32 s5, s5, 5
    s_lshl_b32 s4, s61, 1
    s_add_u32 s5, s5, s4
    s_add_u32 s5, s5, s3
    s_lshr_b32 s14, s5, 3
    s_lshl_b32 s14, s14, 7
    s_and_b32 s4, s5, 7
    s_lshl_b32 s4, s4, 2
    s_add_u32 s14, s14, s4
    s_lshl_b32 s15, s64, 10
    s_add_u32 s15, s15, s14
    v_and_b32 v3, 1, v0
    v_lshlrev_b32 v4, 1, v3
    v_lshl_add_u32 v4, v2, 5, v4
    buffer_load_ushort v20, v4, s[48:51], s15 offen
    buffer_load_ushort v21, v4, s[52:55], s14 offen
    v_lshrrev_b32 v12, 1, v0
    v_min_u32 v13, 13, v12
    v_cmp_gt_u32 s[8:9], 14, v12
    v_lshlrev_b32 v12, 11, v12
    v_lshl_add_u32 v12, v3, 4, v12
    v_lshlrev_b32 v13, 11, v13
    v_lshl_add_u32 v13, v3, 4, v13
    s_mul_i32 s6, s64, 159744
    s_lshl_b32 s5, s5, 5
    s_add_u32 s6, s6, s5
    s_add_u32 s6, s6, 1310720
    s_add_u32 s7, s6, 131072
    s_add_u32 s5, s6, 65536
    s_sleep 6
    s_mov_b32 s13, 0
L_poll23:
    buffer_load_dwordx4 v[16:19], v13, s[44:47], s7 offen sc1
    buffer_load_dwordx4 v[28:31], v12, s[44:47], s6 offen sc1
    buffer_load_dwordx4 v[36:39], v12, s[44:47], s5 offen sc1
    s_waitcnt vmcnt(0)
L_chk24:
    v_xor_b32 v14, s12, v19
    v_bitop3_b32 v14, v14, v31, s12 bitop3:0xf6
    v_bitop3_b32 v14, v14, v39, s12 bitop3:0xf6
    v_cmp_ne_u32 vcc, 0, v14
    s_nop 3
    s_cbranch_vccz L_done25
    s_mov_b64 exec, vcc
    s_add_u32 s13, s13, 1
    s_cmp_ge_u32 s13, 100000
    s_cbranch_scc1 L_done25
    s_sleep 1
    s_branch L_poll23
L_done25:
    s_mov_b64 exec, -1
    v_cndmask_b32 v16, 0, v16, s[8:9]
    v_cndmask_b32 v17, 0, v17, s[8:9]
    v_lshlrev_b32 v24, 16, v16
    v_and_b32 v25, 0xffff0000, v16
    v_lshlrev_b32 v26, 16, v17
    v_and_b32 v27, 0xffff0000, v17
    v_lshlrev_b32 v32, 16, v28
    v_and_b32 v33, 0xffff0000, v28
    v_lshlrev_b32 v34, 16, v29
    v_and_b32 v35, 0xffff0000, v29
    v_lshlrev_b32 v40, 16, v36
    v_and_b32 v41, 0xffff0000, v36
    v_lshlrev_b32 v42, 16, v37
    v_and_b32 v43, 0xffff0000, v37
    v_add_f32 v32, v32, v40
    v_add_f32 v33, v33, v41
    v_add_f32 v34, v34, v42
    v_add_f32 v35, v35, v43
    v_permlane32_swap_b32 v24, v26
    v_permlane32_swap_b32 v25, v27
    v_permlane32_swap_b32 v32, v34
    v_permlane32_swap_b32 v33, v35
    v_add_f32 v24, v24, v26
    v_add_f32 v25, v25, v27
    v_add_f32 v32, v32, v34
    v_add_f32 v33, v33, v35
    v_permlane16_swap_b32 v24, v25
    s_nop 0
    v_permlane16_swap_b32 v32, v33
    v_add_f32 v24, v24, v25
    v_add_f32 v32, v32, v33
    s_nop 0
    v_add_f32_dpp v24, v24, v24 row_ror:8 row_mask:0xf bank_mask:0xf
    v_add_f32_dpp v32, v32, v32 row_ror:8 row_mask:0xf bank_mask:0xf
    s_nop 0
    v_add_f32_dpp v24, v24, v24 row_ror:4 row_mask:0xf bank_mask:0xf
    v_add_f32_dpp v32, v32, v32 row_ror:4 row_mask:0xf bank_mask:0xf
    s_nop 0
    v_add_f32_dpp v24, v24, v24 quad_perm:[2,3,0,1] row_mask:0xf bank_mask:0xf
    v_add_f32_dpp v32, v32, v32 quad_perm:[2,3,0,1] row_mask:0xf bank_mask:0xf
    v_lshlrev_b32 v21, 16, v21
    v_lshlrev_b32 v20, 16, v20
    v_add_f32 v22, v24, v21
    v_mul_f32 v23, 0xbfb8aa3b, v22
    v_exp_f32 v23, v23
    s_nop 0
    v_add_f32 v23, 1.0, v23
    v_rcp_f32 v23, v23
    s_nop 0
    v_mul_f32 v22, v22, v23
    v_fma_f32 v32, v32, v22, v20
    v_cvt_pk_bf16_f32 v32, v32, v32
    s_mov_b32 s8, 0x00030003
    s_mov_b32 s9, 0x00030003
    s_mov_b64 exec, s[8:9]
    buffer_store_short v32, v4, s[56:59], s15 offen
    s_endpgm
L_exit:
    s_endpgm
.section .rodata,"a"
.p2align 6
.amdhsa_kernel recurrent_scan__compressed_kv_cla__dense_activation_gelu__decode_kernel
  .amdhsa_next_free_vgpr 256
  .amdhsa_next_free_sgpr 102
  .amdhsa_accum_offset 256
  .amdhsa_group_segment_fixed_size 0
  .amdhsa_kernarg_size 112
  .amdhsa_user_sgpr_count 2
  .amdhsa_user_sgpr_kernarg_segment_ptr 1
  .amdhsa_system_sgpr_workgroup_id_x 1
.end_amdhsa_kernel
```
